```python
import torch

def _softmax(x, axis=-1):
    return torch.softmax(x, dim=axis)
def _gelu(x):
    return torch.nn.functional.gelu(x, approximate="tanh")
def _silu(x):
    return torch.nn.functional.silu(x)
def _sigmoid(x):
    return torch.sigmoid(x)
def _layernorm(x, axis=-1, eps=1e-5):
    m = x.mean(dim=axis, keepdim=True)
    v = x.var(dim=axis, keepdim=True, unbiased=False)
    return (x - m) / torch.sqrt(v + eps)
def _scatter_add(tgt, idx, src, axis=0):
    return tgt.clone().index_add_(axis, idx, src)
def _segment_sum(src, seg, n):
    out = torch.zeros((n,) + src.shape[1:], dtype=src.dtype)
    return out.index_add_(0, seg, src)
def _pad(x, pw):
    flat = tuple(v for pair in reversed(pw) for v in pair)
    return torch.nn.functional.pad(x, flat)

kernel_name = 'parallel_sum__gqa_block_cached__mixer_channel_mlp__decode'

def setup_inputs():

    _w = (lambda a: (lambda t: t.to(torch.bfloat16) if t.is_floating_point() else t)(torch.as_tensor(a)))
    def _A_setup():
        B, Sq, D = 4, 1, 1024
        Hq, Hkv, Sk, Dh = 32, 4, 16384, 128
        assert Hq % Hkv == 0, (Hq, Hkv)
        return {
            "x": _w((lambda *s: torch.randn(*s, dtype=torch.bfloat16) * 0.05)(B, Sq, D)),
            "k_cache": _w((lambda *s: torch.randn(*s, dtype=torch.bfloat16) * 3.2)(B, Hkv, Sk, Dh)),
            "v_cache": _w((lambda *s: torch.randn(*s, dtype=torch.bfloat16) * 0.4)(B, Hkv, Sk, Dh)),
            "wq": _w((lambda *s: torch.randn(*s, dtype=torch.bfloat16) * 3.2)(D, Hq * Dh) * (D ** -0.5)),
            "wo": _w((lambda *s: torch.randn(*s, dtype=torch.bfloat16) * 0.4)(Hq * Dh, D) * ((Hq * Dh) ** -0.5)),
        }
    _A_in = _A_setup()

    def _B_setup():
        B, S, D, F = 4, 1, 1024, 3584
        return {
            "x": _w((lambda *s: torch.randn(*s, dtype=torch.bfloat16) * 0.05)(B, S, D)),
            "w1": _w((lambda *s: torch.randn(*s, dtype=torch.bfloat16) * 3.2)(D, F) * (D ** -0.5)),
            "b1": _w((lambda *s: torch.randn(*s, dtype=torch.bfloat16) * 1.6)(F)),
            "w2": _w((lambda *s: torch.randn(*s, dtype=torch.bfloat16) * 0.1)(F, D) * (F ** -0.5)),
            "b2": _w((lambda *s: torch.randn(*s, dtype=torch.bfloat16) * 0.1)(D)),
        }
    _B_in = _B_setup()

    return {
        "A_x": _A_in["x"],
        "A_k_cache": _A_in["k_cache"],
        "A_v_cache": _A_in["v_cache"],
        "A_wq": _A_in["wq"],
        "A_wo": _A_in["wo"],
        "B_x": _B_in["x"],
        "B_w1": _B_in["w1"],
        "B_b1": _B_in["b1"],
        "B_w2": _B_in["w2"],
        "B_b2": _B_in["b2"],
    }

def reference(A_x, A_k_cache, A_v_cache, A_wq, A_wo, B_x, B_w1, B_b1, B_w2, B_b2):
    def _A_ref(x, k_cache, v_cache, wq, wo):
        B, Sq, D = x.shape
        Hq, Dh = 32, 128
        Hkv = k_cache.shape[1]
        rep = Hq // Hkv
        q = (lambda x, *d: x.permute(*d))((x @ wq).reshape(B, Sq, Hq, Dh), 0, 2, 1, 3)
        k = (lambda x, n, axis: torch.repeat_interleave(x, n, dim=axis))(k_cache, rep, axis=1)
        v = (lambda x, n, axis: torch.repeat_interleave(x, n, dim=axis))(v_cache, rep, axis=1)
        scores = torch.einsum("bhqd,bhkd->bhqk", q, k) * (Dh ** -0.5)
        p = _softmax(scores, axis=-1)
        o = torch.einsum("bhqk,bhkd->bhqd", p, v)
        return (lambda x, *d: x.permute(*d))(o, 0, 2, 1, 3).reshape(B, Sq, Hq * Dh) @ wo

    def _B_ref(x, w1, b1, w2, b2):
        y = _layernorm(x, axis=-1)
        h = _gelu(torch.einsum("bsd,df->bsf", y, w1) + b1)
        return torch.einsum("bsf,fd->bsd", h, w2) + b2

    x = A_x
    xn = _layernorm(x, axis=-1)
    return x + _A_ref(xn, A_k_cache, A_v_cache, A_wq, A_wo) + _B_ref(xn, B_w1, B_b1, B_w2, B_b2)
```

```asm
; @launch grid=(256,1,1) block=(512,1,1) lds=153600
.amdgcn_target "amdgcn-amd-amdhsa--gfx950"
.text
.globl parallel_sum__gqa_block_cached__mixer_channel_mlp__decode_kernel
.p2align 8
.type parallel_sum__gqa_block_cached__mixer_channel_mlp__decode_kernel,@function
parallel_sum__gqa_block_cached__mixer_channel_mlp__decode_kernel:
    s_cmp_ge_u32 s2, 256
    s_cbranch_scc1 L_end
    s_load_dwordx16 s[64:79], s[0:1], 0
    s_load_dwordx8 s[80:87], s[0:1], 64
    s_load_dwordx2 s[88:89], s[0:1], 96
    s_memrealtime s[92:93]
    s_getpc_b64 s[90:91]
L_pcbase:
    v_lshrrev_b32 v27, 6, v0
    v_and_b32 v0, 63, v0
    v_readfirstlane_b32 s3, v27
    v_lshlrev_b32 v3, 4, v0
    s_and_b32 s44, s2, 0xf8
    s_lshr_b32 s56, s2, 3
    s_add_u32 s44, s44, s3
    s_and_b32 s44, s44, 31
    s_min_u32 s44, s44, 16
    s_lshl_b32 s44, s44, 10
    v_add_u32 v28, s44, v3
    global_load_dwordx4 v[248:251], v28, s[90:91]
    s_and_b32 s57, s2, 7
    s_and_b32 s59, s2, 31
    s_lshr_b32 s100, s2, 5
    s_lshl_b32 s47, s59, 3
    s_add_u32 s47, s47, s100
    s_and_b32 s44, s3, 3
    s_lshl_b32 s44, s44, 11
    v_lshlrev_b32 v29, 5, v0
    v_add_u32 v29, s44, v29
    v_lshrrev_b32 v27, 4, v0
    v_and_b32 v28, 15, v0
    v_lshlrev_b32 v31, 4, v28
    v_lshl_add_u32 v12, v27, 15, v31
    v_mul_u32_u24 v13, 28672, v27
    v_add_u32 v13, v13, v31
    v_mov_b32 v30, 0
    s_lshl_b32 s44, s100, 7
    s_lshl_b32 s45, s3, 4
    s_add_u32 s45, s44, s45
    s_lshl_b32 s44, s59, 8
    s_lshl_b32 s60, s45, 13
    s_add_u32 s60, s60, s44
    s_mul_i32 s61, s45, 7168
    s_add_u32 s61, s61, s44
    s_mov_b32 s14, 8388608
    s_mov_b32 s15, 0x20000
    s_mov_b32 s19, 0x20000
    s_cmp_lt_u32 s59, 28
    s_cselect_b32 s18, 7340032, 0
    s_waitcnt lgkmcnt(0)
    global_load_dwordx4 v[192:195], v29, s[64:65]
    global_load_dwordx4 v[196:199], v29, s[64:65] offset:16
    global_load_dword v2, v30, s[88:89]
    s_mov_b64 s[12:13], s[70:71]
    buffer_load_dwordx4 v[32:35], v12, s[12:15], s60 offen nt
    s_add_u32 s60, s60, 8192
    buffer_load_dwordx4 v[36:39], v12, s[12:15], s60 offen nt
    s_add_u32 s60, s60, 8192
    buffer_load_dwordx4 v[40:43], v12, s[12:15], s60 offen nt
    s_add_u32 s60, s60, 8192
    buffer_load_dwordx4 v[44:47], v12, s[12:15], s60 offen nt
    s_mov_b64 s[16:17], s[76:77]
    s_mov_b32 s50, 0x05040100
    s_mov_b32 s51, 0x07060302
    s_mov_b32 s52, 0xffffff00
    s_mov_b32 s53, 0xffff0000
    s_mov_b32 s54, 0x3db504f3
    s_mov_b32 s55, 0x3fb8aa3b
    s_mov_b32 s58, 0x20000
    s_lshl_b32 s46, s3, 14
    s_and_b32 s43, s47, 0xf0
    s_lshl_b32 s44, s100, 1
    s_add_u32 s43, s43, s44
    s_and_b32 s44, s2, 1
    s_add_u32 s43, s43, s44
    s_lshl_b32 s43, s43, 18
    s_lshl_b32 s44, s3, 12
    s_add_u32 s43, s43, s44
    v_lshl_add_u32 v14, v27, 16, v31
    s_mov_b32 s4, s66
    s_mov_b32 s5, s67
    s_mov_b32 s6, 67108864
    s_mov_b32 s7, 0x20000
    s_mov_b32 s8, s68
    s_mov_b32 s9, s69
    s_mov_b32 s10, 67108864
    s_mov_b32 s11, 0x20000
    s_mov_b32 s20, s72
    s_mov_b32 s21, s73
    s_mov_b32 s22, 8388608
    s_mov_b32 s23, 0x20000
    s_mov_b32 s24, s80
    s_mov_b32 s25, s81
    s_mov_b32 s26, 7340032
    s_mov_b32 s27, 0x20000
    s_cmp_lt_u32 s56, 28
    s_cselect_b32 s26, s26, 0
    s_mov_b32 s28, s88
    s_mov_b32 s29, s89
    s_mov_b32 s30, 3899392
    s_mov_b32 s31, 0x20000
    s_mov_b64 s[32:33], s[64:65]
    s_mov_b64 s[34:35], s[78:79]
    s_mov_b64 s[0:1], s[64:65]
    s_mov_b64 s[36:37], s[82:83]
    s_mov_b64 s[38:39], s[84:85]
    s_mov_b64 s[40:41], s[88:89]
    s_mov_b32 s88, s92
    s_mov_b32 s86, s92
    v_lshrrev_b32 v31, 2, v28
    v_and_b32 v30, 1, v31
    v_cmp_eq_u32 vcc, 1, v30
    v_mov_b32 v112, 0x0c0c0100
    v_mov_b32 v113, 0x01000c0c
    v_mov_b32 v114, 0x0202
    v_mov_b32 v115, 0x02020000
    v_mov_b32 v116, 0x0c0c0c0c
    v_cndmask_b32 v112, v112, v113, vcc
    v_cndmask_b32 v114, v114, v115, vcc
    v_cmp_gt_u32 vcc, 2, v31
    s_nop 1
    v_cndmask_b32 v17, v116, v112, vcc
    v_cndmask_b32 v18, v112, v116, vcc
    v_add_u32 v112, v112, v114
    v_cndmask_b32 v19, v116, v112, vcc
    v_cndmask_b32 v20, v112, v116, vcc
    v_add_u32 v112, v112, v114
    v_cndmask_b32 v21, v116, v112, vcc
    v_cndmask_b32 v22, v112, v116, vcc
    v_add_u32 v112, v112, v114
    v_cndmask_b32 v23, v116, v112, vcc
    v_cndmask_b32 v24, v112, v116, vcc
    v_lshl_add_u32 v4, v27, 2, 0
    v_xor_b32 v4, v4, v28
    v_lshlrev_b32 v4, 4, v4
    v_lshl_add_u32 v4, v27, 8, v4
    v_lshl_add_u32 v5, v27, 2, 1
    v_xor_b32 v5, v5, v28
    v_lshlrev_b32 v5, 4, v5
    v_lshl_add_u32 v5, v27, 8, v5
    v_lshl_add_u32 v6, v27, 2, 2
    v_xor_b32 v6, v6, v28
    v_lshlrev_b32 v6, 4, v6
    v_lshl_add_u32 v6, v27, 8, v6
    v_lshl_add_u32 v7, v27, 2, 3
    v_xor_b32 v7, v7, v28
    v_lshlrev_b32 v7, 4, v7
    v_lshl_add_u32 v7, v27, 8, v7
    v_lshlrev_b32 v30, 2, v28
    v_add_u32 v30, 152320, v30
    v_mov_b32 v31, 0
    ds_write_b32 v30, v31
    s_and_b32 s44, s3, 3
    s_lshl_b32 s44, s44, 8
    s_lshl_b32 s45, s100, 8
    s_sub_u32 s44, s44, s45
    s_add_u32 s44, s44, 131072
    v_lshlrev_b32 v29, 5, v0
    v_add_u32 v29, s44, v29
    s_lshl_b32 s45, s100, 3
    s_lshl_b64 s[94:95], 0xff, s45
    v_lshrrev_b32 v27, 4, v0
    v_and_b32 v28, 15, v0
    v_and_b32 v30, 3, v28
    v_lshrrev_b32 v31, 2, v28
    v_lshl_add_u32 v30, v30, 2, v31
    v_lshlrev_b32 v30, 8, v30
    v_add_u32 v30, s46, v30
    v_xor_b32 v31, v27, v28
    v_xor_b32 v8, 0, v31
    v_lshl_add_u32 v8, v8, 4, v30
    v_xor_b32 v9, 4, v31
    v_lshl_add_u32 v9, v9, 4, v30
    v_xor_b32 v10, 8, v31
    v_lshl_add_u32 v10, v10, 4, v30
    v_xor_b32 v11, 12, v31
    v_lshl_add_u32 v11, v11, 4, v30
    v_cmp_gt_u32 vcc, 8, v28
    s_nop 1
    v_cndmask_b32 v15, 0, -1, vcc
    v_not_b32 v16, v15
    s_lshl_b32 s90, s56, 7
    s_add_u32 s90, s90, s3
    s_lshl_b32 s63, s90, 11
    s_lshl_b32 s91, s57, 8
    s_add_u32 s63, s63, s91
    s_mov_b32 s62, s63
    s_min_u32 s90, s59, 27
    s_lshl_b32 s90, s90, 7
    s_add_u32 s90, s90, s3
    s_lshl_b32 s90, s90, 1
    s_mov_b32 s48, 0
    v_lshlrev_b32 v30, 6, v27
    v_add_u32 v30, s90, v30
    global_load_ushort v252, v30, s[34:35] offset:0
    global_load_ushort v253, v30, s[34:35] offset:16
    global_load_ushort v254, v30, s[34:35] offset:32
    global_load_ushort v255, v30, s[34:35] offset:48
    s_lshr_b32 s90, s56, 4
    s_lshl_b32 s90, s90, 2
    s_and_b32 s91, s56, 3
    s_add_u32 s90, s90, s91
    s_bfe_u32 s91, s56, 0x20002
    s_lshl_b32 s91, s91, 5
    s_add_u32 s90, s90, s91
    s_lshl_b32 s91, s57, 7
    s_add_u32 s90, s90, s91
    s_lshl_b32 s42, s90, 1
    v_bfe_u32 v31, v0, 2, 2
    v_lshlrev_b32 v30, 4, v31
    v_add_u32 v30, s42, v30
    global_load_ushort v26, v30, s[36:37]
    v_and_b32 v31, 3, v0
    v_lshl_add_u32 v30, v31, 11, v30
    global_load_ushort v25, v30, s[32:33]
    s_waitcnt vmcnt(10)
    v_add_u32 v2, 1, v2
    v_mov_b32 v1, 0xff
    v_readfirstlane_b32 s49, v2
    s_getreg_b32 s101, hwreg(HW_REG_XCC_ID, 0, 4)
    s_lshl_b32 s101, s101, 8
    s_and_b32 s32, s49, 0xffff
    s_add_u32 s33, s49, 27445
    s_and_b32 s33, s33, 0xffff
    s_add_u32 s34, s49, 54890
    s_and_b32 s34, s34, 0xffff
    s_add_u32 s35, s49, 82335
    s_and_b32 s35, s35, 0xffff
    s_cmp_lg_u32 s3, 0
    s_cbranch_scc1 L_noxi
    v_mov_b32 v120, s101
    v_mov_b32 v121, s101
    v_mov_b32 v122, s101
    v_mov_b32 v123, s101
    v_bfi_b32 v120, v1, s32, v120
    v_bfi_b32 v121, v1, s33, v121
    v_bfi_b32 v122, v1, s34, v122
    v_bfi_b32 v123, v1, s35, v123
    s_lshl_b32 s90, s57, 5
    s_add_u32 s90, s90, s56
    s_lshl_b32 s90, s90, 7
    s_add_u32 s90, s90, 3866624
    s_mov_b64 exec, 0xff
    buffer_store_dwordx4 v[120:123], v3, s[28:31], s90 offen
    s_mov_b64 exec, -1
    s_nop 1
L_noxi:
    s_mov_b64 s[12:13], s[28:29]
    v_lshlrev_b32 v200, 16, v192
    v_and_b32 v201, s53, v192
    v_lshlrev_b32 v202, 16, v193
    v_and_b32 v203, s53, v193
    v_lshlrev_b32 v204, 16, v194
    v_and_b32 v205, s53, v194
    v_lshlrev_b32 v206, 16, v195
    v_and_b32 v207, s53, v195
    v_lshlrev_b32 v208, 16, v196
    v_and_b32 v209, s53, v196
    v_lshlrev_b32 v210, 16, v197
    v_and_b32 v211, s53, v197
    v_lshlrev_b32 v212, 16, v198
    v_and_b32 v213, s53, v198
    v_lshlrev_b32 v214, 16, v199
    v_and_b32 v215, s53, v199
    v_pk_add_f32 v[216:217], v[200:201], v[202:203]
    v_pk_add_f32 v[218:219], v[204:205], v[206:207]
    v_pk_add_f32 v[220:221], v[208:209], v[210:211]
    v_pk_add_f32 v[222:223], v[212:213], v[214:215]
    v_pk_add_f32 v[216:217], v[216:217], v[218:219]
    v_pk_add_f32 v[220:221], v[220:221], v[222:223]
    v_pk_add_f32 v[216:217], v[216:217], v[220:221]
    v_add_f32 v27, v216, v217
    s_waitcnt vmcnt(8)
    s_add_u32 s44, s43, 0
    s_add_u32 m0, s46, 0
    s_nop 0
    buffer_load_dwordx4 v4, s[4:7], s44 offen offset:0 nt lds
    v_add_f32_dpp v27, v27, v27 row_ror:8 row_mask:0xf bank_mask:0xf
    s_nop 1
    v_add_f32_dpp v27, v27, v27 row_ror:4 row_mask:0xf bank_mask:0xf
    s_nop 1
    v_add_f32_dpp v27, v27, v27 row_ror:2 row_mask:0xf bank_mask:0xf
    s_nop 1
    v_add_f32_dpp v27, v27, v27 row_ror:1 row_mask:0xf bank_mask:0xf
    v_mov_b32 v28, v27
    s_nop 1
    v_permlane16_swap_b32 v28, v27
    v_add_f32 v27, v27, v28
    v_mov_b32 v28, v27
    s_nop 1
    v_permlane32_swap_b32 v28, v27
    v_add_f32 v27, v27, v28
    v_mul_f32 v27, 0xba800000, v27
    s_waitcnt vmcnt(8)
    buffer_load_dwordx4 v5, s[4:7], s44 offen offset:1024 nt lds
    v_mov_b32 v112, v27
    v_mov_b32 v113, v27
    v_pk_add_f32 v[216:217], v[200:201], v[112:113]
    v_pk_add_f32 v[218:219], v[202:203], v[112:113]
    v_pk_add_f32 v[220:221], v[204:205], v[112:113]
    v_pk_add_f32 v[222:223], v[206:207], v[112:113]
    v_pk_add_f32 v[224:225], v[208:209], v[112:113]
    v_pk_add_f32 v[226:227], v[210:211], v[112:113]
    v_pk_add_f32 v[228:229], v[212:213], v[112:113]
    v_pk_add_f32 v[230:231], v[214:215], v[112:113]
    v_pk_mul_f32 v[114:115], v[216:217], v[216:217]
    v_pk_mul_f32 v[116:117], v[218:219], v[218:219]
    v_pk_fma_f32 v[114:115], v[220:221], v[220:221], v[114:115]
    v_pk_fma_f32 v[116:117], v[222:223], v[222:223], v[116:117]
    v_pk_fma_f32 v[114:115], v[224:225], v[224:225], v[114:115]
    v_pk_fma_f32 v[116:117], v[226:227], v[226:227], v[116:117]
    v_pk_fma_f32 v[114:115], v[228:229], v[228:229], v[114:115]
    v_pk_fma_f32 v[116:117], v[230:231], v[230:231], v[116:117]
    v_pk_add_f32 v[114:115], v[114:115], v[116:117]
    v_add_f32 v30, v114, v115
    s_waitcnt vmcnt(8)
    buffer_load_dwordx4 v6, s[4:7], s44 offen offset:2048 nt lds
    v_add_f32_dpp v30, v30, v30 row_ror:8 row_mask:0xf bank_mask:0xf
    s_nop 1
    v_add_f32_dpp v30, v30, v30 row_ror:4 row_mask:0xf bank_mask:0xf
    s_nop 1
    v_add_f32_dpp v30, v30, v30 row_ror:2 row_mask:0xf bank_mask:0xf
    s_nop 1
    v_add_f32_dpp v30, v30, v30 row_ror:1 row_mask:0xf bank_mask:0xf
    v_mov_b32 v28, v30
    s_nop 1
    v_permlane16_swap_b32 v28, v30
    v_add_f32 v30, v30, v28
    v_mov_b32 v28, v30
    s_nop 1
    v_permlane32_swap_b32 v28, v30
    v_add_f32 v30, v30, v28
    v_mul_f32 v30, 0x3a800000, v30
    v_cvt_pk_bf16_f32 v28, v27, v30
    v_lshlrev_b32 v27, 16, v28
    v_and_b32 v30, s53, v28
    v_add_f32 v30, 0x3727c5ac, v30
    v_mov_b32 v112, v27
    v_mov_b32 v113, v27
    v_cvt_pk_bf16_f32 v30, v30, v30
    v_and_b32 v30, s53, v30
    v_sqrt_f32 v30, v30
    v_pk_add_f32 v[200:201], v[200:201], v[112:113]
    v_pk_add_f32 v[202:203], v[202:203], v[112:113]
    v_pk_add_f32 v[204:205], v[204:205], v[112:113]
    v_pk_add_f32 v[206:207], v[206:207], v[112:113]
    v_pk_add_f32 v[208:209], v[208:209], v[112:113]
    v_pk_add_f32 v[210:211], v[210:211], v[112:113]
    v_pk_add_f32 v[212:213], v[212:213], v[112:113]
    v_pk_add_f32 v[214:215], v[214:215], v[112:113]
    v_cvt_pk_bf16_f32 v30, v30, v30
    v_and_b32 v30, s53, v30
    v_rcp_f32 v114, v30
    v_rcp_f32 v115, v30
    s_waitcnt vmcnt(2)
    buffer_load_dwordx4 v7, s[4:7], s44 offen offset:3072 nt lds
    v_cvt_pk_bf16_f32 v216, v200, v201
    v_lshlrev_b32 v200, 16, v216
    v_and_b32 v201, s53, v216
    v_cvt_pk_bf16_f32 v217, v202, v203
    v_lshlrev_b32 v202, 16, v217
    v_and_b32 v203, s53, v217
    v_cvt_pk_bf16_f32 v218, v204, v205
    v_lshlrev_b32 v204, 16, v218
    v_and_b32 v205, s53, v218
    v_cvt_pk_bf16_f32 v219, v206, v207
    v_lshlrev_b32 v206, 16, v219
    v_and_b32 v207, s53, v219
    v_cvt_pk_bf16_f32 v220, v208, v209
    v_lshlrev_b32 v208, 16, v220
    v_and_b32 v209, s53, v220
    v_cvt_pk_bf16_f32 v221, v210, v211
    v_lshlrev_b32 v210, 16, v221
    v_and_b32 v211, s53, v221
    v_cvt_pk_bf16_f32 v222, v212, v213
    v_lshlrev_b32 v212, 16, v222
    v_and_b32 v213, s53, v222
    v_cvt_pk_bf16_f32 v223, v214, v215
    v_lshlrev_b32 v214, 16, v223
    v_and_b32 v215, s53, v223
    v_pk_mul_f32 v[200:201], v[200:201], v[114:115]
    v_pk_mul_f32 v[202:203], v[202:203], v[114:115]
    v_pk_mul_f32 v[204:205], v[204:205], v[114:115]
    v_pk_mul_f32 v[206:207], v[206:207], v[114:115]
    v_pk_mul_f32 v[208:209], v[208:209], v[114:115]
    v_pk_mul_f32 v[210:211], v[210:211], v[114:115]
    v_pk_mul_f32 v[212:213], v[212:213], v[114:115]
    v_pk_mul_f32 v[214:215], v[214:215], v[114:115]
    v_cvt_pk_bf16_f32 v232, v200, v201
    v_cvt_pk_bf16_f32 v233, v202, v203
    v_cvt_pk_bf16_f32 v234, v204, v205
    v_cvt_pk_bf16_f32 v235, v206, v207
    v_cvt_pk_bf16_f32 v236, v208, v209
    v_cvt_pk_bf16_f32 v237, v210, v211
    v_cvt_pk_bf16_f32 v238, v212, v213
    v_cvt_pk_bf16_f32 v239, v214, v215
    s_cmp_lt_u32 s3, 4
    s_cselect_b64 exec, s[94:95], 0
    s_cbranch_scc0 L_noxn
    ds_write_b128 v29, v[232:235]
    ds_write_b128 v29, v[236:239] offset:16
L_noxn:
    s_mov_b64 exec, -1
    v_and_b32 v27, 3, v0
    v_lshlrev_b32 v27, 8, v27
    v_lshrrev_b32 v28, 4, v0
    v_lshl_add_u32 v27, v28, 3, v27
    s_lshl_b32 s91, s3, 5
    s_add_u32 s91, s91, 131072
    v_add_u32 v250, s91, v27
    s_cmp_eq_u32 s3, 1
    s_cselect_b32 s14, s30, 0
    s_lshl_b32 s90, s57, 12
    s_add_u32 s90, s90, 3866624
    v_lshrrev_b32 v31, 2, v0
    v_lshlrev_b32 v31, 7, v31
    v_and_b32 v30, 0x30, v3
    v_add_u32 v31, v31, v30
    buffer_load_dwordx4 v[120:123], v31, s[12:15], s90 offen nt
    buffer_load_dwordx4 v[124:127], v31, s[12:15], s90 offen offset:2048 nt
    s_waitcnt lgkmcnt(0)
    s_waitcnt lgkmcnt(0)
    s_sub_u32 s89, s86, s88
    s_memrealtime s[86:87]
    s_cmp_gt_i32 s89, 196
    s_cbranch_scc1 L_sk0
    s_waitcnt vmcnt(4)
L_sk0:
    s_add_u32 s44, s43, 32768
    s_add_u32 m0, s46, 4096
    s_nop 0
    buffer_load_dwordx4 v4, s[4:7], s44 offen offset:0 nt lds
    s_barrier
    ds_read_b64 v[200:201], v250
    v_and_b32 v27, 15, v0
    v_lshlrev_b32 v251, 6, v27
    v_lshl_add_u32 v251, v28, 12, v251
    s_and_b32 s91, s3, 1
    s_lshl_b32 s91, s91, 10
    s_lshr_b32 s90, s3, 1
    s_lshl_b32 s90, s90, 4
    s_add_u32 s91, s91, s90
    s_add_u32 s91, s91, 133120
    v_add_u32 v251, s91, v251
    v_lshrrev_b32 v249, 2, v27
    v_lshlrev_b32 v249, 8, v249
    v_lshl_add_u32 v249, v28, 12, v249
    v_and_b32 v27, 0x30, v3
    v_add_u32 v249, v249, v27
    s_lshr_b32 s91, s3, 2
    s_lshl_b32 s91, s91, 10
    s_and_b32 s90, s3, 3
    s_lshl_b32 s90, s90, 6
    s_add_u32 s91, s91, s90
    s_add_u32 s91, s91, 133120
    v_add_u32 v249, s91, v249
    s_lshl_b32 s91, s3, 11
    s_add_u32 s91, s91, 133120
    v_add_u32 v248, s91, v3
    s_waitcnt lgkmcnt(0)
    v_perm_b32 v204, v201, v200, v17
    v_perm_b32 v205, v201, v200, v18
    v_perm_b32 v206, v201, v200, v19
    v_perm_b32 v207, v201, v200, v20
    v_perm_b32 v208, v201, v200, v21
    v_perm_b32 v209, v201, v200, v22
    v_perm_b32 v210, v201, v200, v23
    v_perm_b32 v211, v201, v200, v24
    v_mfma_f32_16x16x16_bf16 v[212:215], v[32:33], v[204:205], 0
    v_mfma_f32_16x16x16_bf16 v[216:219], v[34:35], v[204:205], 0
    v_mfma_f32_16x16x16_bf16 v[212:215], v[36:37], v[206:207], v[212:215]
    v_mfma_f32_16x16x16_bf16 v[216:219], v[38:39], v[206:207], v[216:219]
    v_mfma_f32_16x16x16_bf16 v[212:215], v[40:41], v[208:209], v[212:215]
    v_mfma_f32_16x16x16_bf16 v[216:219], v[42:43], v[208:209], v[216:219]
    v_mfma_f32_16x16x16_bf16 v[212:215], v[44:45], v[210:211], v[212:215]
    v_mfma_f32_16x16x16_bf16 v[216:219], v[46:47], v[210:211], v[216:219]
    s_lshl_b32 s90, s59, 14
    s_lshl_b32 s91, s3, 11
    s_add_u32 s90, s90, s91
    s_lshl_b32 s91, s100, 8
    s_add_u32 s90, s90, s91
    s_add_u32 s91, s90, 65536
    s_nop 0
    ds_write_b128 v248, v[212:215]
    ds_write_b128 v248, v[216:219] offset:1024
    s_waitcnt lgkmcnt(0)
    s_sub_u32 s89, s86, s88
    s_memrealtime s[86:87]
    s_cmp_gt_i32 s89, 225
    s_cbranch_scc1 L_sk1
    s_waitcnt vmcnt(4)
L_sk1:
    buffer_load_dwordx4 v5, s[4:7], s44 offen offset:1024 nt lds
    s_cmp_lg_u32 s3, 1
    s_cbranch_scc1 L_xc2
    s_waitcnt vmcnt(2)
    s_and_b32 s92, s32, 0xff
    s_or_b32 s92, s92, s101
    v_xor_b32 v31, s92, v120
    v_bitop3_b32 v31, v31, v124, s92 bitop3:0xf6
    s_and_b32 s92, s33, 0xff
    s_or_b32 s92, s92, s101
    v_bitop3_b32 v31, v31, v121, s92 bitop3:0xf6
    v_bitop3_b32 v31, v31, v125, s92 bitop3:0xf6
    s_and_b32 s92, s34, 0xff
    s_or_b32 s92, s92, s101
    v_bitop3_b32 v31, v31, v122, s92 bitop3:0xf6
    v_bitop3_b32 v31, v31, v126, s92 bitop3:0xf6
    s_and_b32 s92, s35, 0xff
    s_or_b32 s92, s92, s101
    v_bitop3_b32 v31, v31, v123, s92 bitop3:0xf6
    v_bitop3_b32 v31, v31, v127, s92 bitop3:0xf6
    v_cmp_ne_u32 vcc, 0, v31
    s_and_b32 s92, s56, 3
    s_lshl_b32 s92, s92, 2
    s_lshl_b32 s92, 0x000f000f, s92
    s_or_b32 s93, vcc_lo, vcc_hi
    s_and_b32 s92, s92, s93
    s_cbranch_scc1 L_xc2
    s_cmp_eq_u32 s93, 0
    s_cselect_b32 s92, 3, 1
    v_mov_b32 v31, 152344
    v_mov_b32 v30, s92
    ds_write_b32 v31, v30
L_xc2:
    s_waitcnt lgkmcnt(0)
    s_barrier
    v_mov_b32 v31, 152344
    ds_read_b32 v31, v31
    ds_read_b128 v[200:203], v251
    ds_read_b128 v[204:207], v251 offset:2048
    s_waitcnt lgkmcnt(0)
    v_pk_add_f32 v[200:201], v[200:201], v[204:205]
    v_pk_add_f32 v[202:203], v[202:203], v[206:207]
    v_mov_b32 v204, v200
    v_mov_b32 v205, v201
    v_mov_b32 v206, v202
    v_mov_b32 v207, v203
    v_permlane16_swap_b32 v204, v200
    v_permlane16_swap_b32 v205, v201
    v_permlane16_swap_b32 v206, v202
    v_permlane16_swap_b32 v207, v203
    v_add_f32 v200, v200, v204
    v_add_f32 v201, v201, v205
    v_add_f32 v202, v202, v206
    v_add_f32 v203, v203, v207
    v_mov_b32 v204, v200
    v_mov_b32 v205, v201
    v_mov_b32 v206, v202
    v_mov_b32 v207, v203
    v_permlane32_swap_b32 v204, v200
    v_permlane32_swap_b32 v205, v201
    v_permlane32_swap_b32 v206, v202
    v_permlane32_swap_b32 v207, v203
    v_add_f32 v200, v200, v204
    v_add_f32 v201, v201, v205
    v_add_f32 v202, v202, v206
    v_add_f32 v203, v203, v207
    v_readfirstlane_b32 s48, v31
    v_add_u32 v200, 0x80, v200
    v_bfi_b32 v200, v1, s32, v200
    v_add_u32 v201, 0x80, v201
    v_bfi_b32 v201, v1, s33, v201
    v_add_u32 v202, 0x80, v202
    v_bfi_b32 v202, v1, s34, v202
    v_add_u32 v203, 0x80, v203
    v_bfi_b32 v203, v1, s35, v203
    s_mov_b64 exec, 0xffff
    s_bitcmp1_b32 s48, 0
    s_cbranch_scc1 L_ls3
    buffer_store_dwordx4 v[200:203], v3, s[28:31], s91 offen sc1
    s_branch L_le3
L_ls3:
    buffer_store_dwordx4 v[200:203], v3, s[28:31], s91 offen
L_le3:
    s_mov_b64 exec, -1
    s_waitcnt lgkmcnt(0)
    s_sub_u32 s89, s86, s88
    s_memrealtime s[86:87]
    s_cmp_gt_i32 s89, 254
    s_cbranch_scc1 L_sk4
    s_waitcnt vmcnt(5)
L_sk4:
    buffer_load_dwordx4 v6, s[4:7], s44 offen offset:2048 nt lds
    s_cmp_gt_i32 s89, 283
    s_cbranch_scc1 L_sk5
    s_waitcnt vmcnt(3)
L_sk5:
    buffer_load_dwordx4 v7, s[4:7], s44 offen offset:3072 nt lds
    v_lshlrev_b32 v200, 16, v232
    v_and_b32 v201, s53, v232
    v_lshlrev_b32 v202, 16, v233
    v_and_b32 v203, s53, v233
    v_lshlrev_b32 v204, 16, v234
    v_and_b32 v205, s53, v234
    v_lshlrev_b32 v206, 16, v235
    v_and_b32 v207, s53, v235
    v_lshlrev_b32 v208, 16, v236
    v_and_b32 v209, s53, v236
    v_lshlrev_b32 v210, 16, v237
    v_and_b32 v211, s53, v237
    v_lshlrev_b32 v212, 16, v238
    v_and_b32 v213, s53, v238
    v_lshlrev_b32 v214, 16, v239
    v_and_b32 v215, s53, v239
    v_pk_add_f32 v[216:217], v[200:201], v[202:203]
    v_pk_add_f32 v[218:219], v[204:205], v[206:207]
    v_pk_add_f32 v[220:221], v[208:209], v[210:211]
    v_pk_add_f32 v[222:223], v[212:213], v[214:215]
    v_pk_add_f32 v[216:217], v[216:217], v[218:219]
    v_pk_add_f32 v[220:221], v[220:221], v[222:223]
    v_pk_add_f32 v[216:217], v[216:217], v[220:221]
    v_add_f32 v27, v216, v217
    s_cmp_gt_i32 s89, 312
    s_cbranch_scc1 L_sk6
    s_waitcnt vmcnt(3)
L_sk6:
    s_add_u32 s44, s43, 65536
    s_add_u32 m0, s46, 8192
    s_nop 0
    buffer_load_dwordx4 v4, s[4:7], s44 offen offset:0 nt lds
    v_add_f32_dpp v27, v27, v27 row_ror:8 row_mask:0xf bank_mask:0xf
    s_nop 1
    v_add_f32_dpp v27, v27, v27 row_ror:4 row_mask:0xf bank_mask:0xf
    s_nop 1
    v_add_f32_dpp v27, v27, v27 row_ror:2 row_mask:0xf bank_mask:0xf
    s_nop 1
    v_add_f32_dpp v27, v27, v27 row_ror:1 row_mask:0xf bank_mask:0xf
    v_mov_b32 v28, v27
    s_nop 1
    v_permlane16_swap_b32 v28, v27
    v_add_f32 v27, v27, v28
    v_mov_b32 v28, v27
    s_nop 1
    v_permlane32_swap_b32 v28, v27
    v_add_f32 v27, v27, v28
    v_mul_f32 v27, 0xba800000, v27
    s_waitcnt lgkmcnt(0)
    s_sub_u32 s89, s86, s88
    s_memrealtime s[86:87]
    s_cmp_gt_i32 s89, 341
    s_cbranch_scc1 L_sk7
    s_waitcnt vmcnt(2)
L_sk7:
    s_waitcnt vmcnt(10)
    buffer_load_dwordx4 v5, s[4:7], s44 offen offset:1024 nt lds
    v_mov_b32 v112, v27
    v_mov_b32 v113, v27
    v_pk_add_f32 v[216:217], v[200:201], v[112:113]
    v_pk_add_f32 v[218:219], v[202:203], v[112:113]
    v_pk_add_f32 v[220:221], v[204:205], v[112:113]
    v_pk_add_f32 v[222:223], v[206:207], v[112:113]
    v_pk_add_f32 v[224:225], v[208:209], v[112:113]
    v_pk_add_f32 v[226:227], v[210:211], v[112:113]
    v_pk_add_f32 v[228:229], v[212:213], v[112:113]
    v_pk_add_f32 v[230:231], v[214:215], v[112:113]
    v_pk_mul_f32 v[114:115], v[216:217], v[216:217]
    v_pk_mul_f32 v[116:117], v[218:219], v[218:219]
    v_pk_fma_f32 v[114:115], v[220:221], v[220:221], v[114:115]
    v_pk_fma_f32 v[116:117], v[222:223], v[222:223], v[116:117]
    v_pk_fma_f32 v[114:115], v[224:225], v[224:225], v[114:115]
    v_pk_fma_f32 v[116:117], v[226:227], v[226:227], v[116:117]
    v_pk_fma_f32 v[114:115], v[228:229], v[228:229], v[114:115]
    v_pk_fma_f32 v[116:117], v[230:231], v[230:231], v[116:117]
    v_pk_add_f32 v[114:115], v[114:115], v[116:117]
    v_add_f32 v30, v114, v115
    s_cmp_gt_i32 s89, 370
    s_cbranch_scc1 L_sk8
    s_waitcnt vmcnt(2)
L_sk8:
    s_waitcnt vmcnt(10)
    buffer_load_dwordx4 v6, s[4:7], s44 offen offset:2048 nt lds
    v_add_f32_dpp v30, v30, v30 row_ror:8 row_mask:0xf bank_mask:0xf
    s_nop 1
    v_add_f32_dpp v30, v30, v30 row_ror:4 row_mask:0xf bank_mask:0xf
    s_nop 1
    v_add_f32_dpp v30, v30, v30 row_ror:2 row_mask:0xf bank_mask:0xf
    s_nop 1
    v_add_f32_dpp v30, v30, v30 row_ror:1 row_mask:0xf bank_mask:0xf
    v_mov_b32 v28, v30
    s_nop 1
    v_permlane16_swap_b32 v28, v30
    v_add_f32 v30, v30, v28
    v_mov_b32 v28, v30
    s_nop 1
    v_permlane32_swap_b32 v28, v30
    v_add_f32 v30, v30, v28
    v_mul_f32 v30, 0x3a800000, v30
    v_cvt_pk_bf16_f32 v28, v27, v30
    v_lshlrev_b32 v27, 16, v28
    v_and_b32 v30, s53, v28
    v_add_f32 v30, 0x3727c5ac, v30
    v_mov_b32 v112, v27
    v_mov_b32 v113, v27
    v_cvt_pk_bf16_f32 v30, v30, v30
    v_and_b32 v30, s53, v30
    v_sqrt_f32 v30, v30
    v_pk_add_f32 v[200:201], v[200:201], v[112:113]
    v_pk_add_f32 v[202:203], v[202:203], v[112:113]
    v_pk_add_f32 v[204:205], v[204:205], v[112:113]
    v_pk_add_f32 v[206:207], v[206:207], v[112:113]
    v_pk_add_f32 v[208:209], v[208:209], v[112:113]
    v_pk_add_f32 v[210:211], v[210:211], v[112:113]
    v_pk_add_f32 v[212:213], v[212:213], v[112:113]
    v_pk_add_f32 v[214:215], v[214:215], v[112:113]
    v_cvt_pk_bf16_f32 v30, v30, v30
    v_and_b32 v30, s53, v30
    v_rcp_f32 v114, v30
    v_rcp_f32 v115, v30
    s_waitcnt lgkmcnt(0)
    s_sub_u32 s89, s86, s88
    s_memrealtime s[86:87]
    s_cmp_gt_i32 s89, 399
    s_cbranch_scc1 L_sk9
    s_waitcnt vmcnt(2)
L_sk9:
    s_waitcnt vmcnt(10)
    buffer_load_dwordx4 v7, s[4:7], s44 offen offset:3072 nt lds
    v_cvt_pk_bf16_f32 v216, v200, v201
    v_lshlrev_b32 v200, 16, v216
    v_and_b32 v201, s53, v216
    v_cvt_pk_bf16_f32 v217, v202, v203
    v_lshlrev_b32 v202, 16, v217
    v_and_b32 v203, s53, v217
    v_cvt_pk_bf16_f32 v218, v204, v205
    v_lshlrev_b32 v204, 16, v218
    v_and_b32 v205, s53, v218
    v_cvt_pk_bf16_f32 v219, v206, v207
    v_lshlrev_b32 v206, 16, v219
    v_and_b32 v207, s53, v219
    v_cvt_pk_bf16_f32 v220, v208, v209
    v_lshlrev_b32 v208, 16, v220
    v_and_b32 v209, s53, v220
    v_cvt_pk_bf16_f32 v221, v210, v211
    v_lshlrev_b32 v210, 16, v221
    v_and_b32 v211, s53, v221
    v_cvt_pk_bf16_f32 v222, v212, v213
    v_lshlrev_b32 v212, 16, v222
    v_and_b32 v213, s53, v222
    v_cvt_pk_bf16_f32 v223, v214, v215
    v_lshlrev_b32 v214, 16, v223
    v_and_b32 v215, s53, v223
    v_pk_mul_f32 v[200:201], v[200:201], v[114:115]
    v_pk_mul_f32 v[202:203], v[202:203], v[114:115]
    v_pk_mul_f32 v[204:205], v[204:205], v[114:115]
    v_pk_mul_f32 v[206:207], v[206:207], v[114:115]
    v_pk_mul_f32 v[208:209], v[208:209], v[114:115]
    v_pk_mul_f32 v[210:211], v[210:211], v[114:115]
    v_pk_mul_f32 v[212:213], v[212:213], v[114:115]
    v_pk_mul_f32 v[214:215], v[214:215], v[114:115]
    v_cvt_pk_bf16_f32 v240, v200, v201
    v_cvt_pk_bf16_f32 v241, v202, v203
    v_cvt_pk_bf16_f32 v242, v204, v205
    v_cvt_pk_bf16_f32 v243, v206, v207
    v_cvt_pk_bf16_f32 v244, v208, v209
    v_cvt_pk_bf16_f32 v245, v210, v211
    v_cvt_pk_bf16_f32 v246, v212, v213
    v_cvt_pk_bf16_f32 v247, v214, v215
    s_cmp_ge_u32 s3, 4
    s_cselect_b64 exec, s[94:95], 0
    s_cbranch_scc0 L_noy
    ds_write_b128 v29, v[240:243] offset:1024
    ds_write_b128 v29, v[244:247] offset:1040
L_noy:
    s_mov_b64 exec, -1
    v_mov_b32 v27, 152324
    v_mov_b32 v28, 1
    s_mov_b64 exec, 1
    ds_add_u32 v27, v28
    s_mov_b64 exec, -1
    s_mov_b64 s[12:13], s[28:29]
    s_cmp_eq_u32 s3, 0
    s_cselect_b32 s14, s30, 0
    s_lshl_b32 s90, s47, 11
    s_add_u32 s94, s90, 65536
    s_memrealtime s[96:97]
    s_bitcmp1_b32 s48, 0
    s_cbranch_scc1 L_ls10
    buffer_load_dwordx4 v[216:219], v3, s[12:15], s94 offen offset:0 sc1
    buffer_load_dwordx4 v[220:223], v3, s[12:15], s94 offen offset:1024 sc1
    s_branch L_le10
L_ls10:
    buffer_load_dwordx4 v[216:219], v3, s[12:15], s94 offen offset:0 nt
    buffer_load_dwordx4 v[220:223], v3, s[12:15], s94 offen offset:1024 nt
L_le10:
    s_waitcnt lgkmcnt(0)
    s_sub_u32 s89, s86, s88
    s_memrealtime s[86:87]
    s_cmp_gt_i32 s89, 428
    s_cbranch_scc1 L_sk11
    s_waitcnt vmcnt(4)
L_sk11:
    s_waitcnt vmcnt(10)
    buffer_load_dwordx4 v[48:51], v13, s[16:19], s61 offen nt
    s_lshr_b32 s90, s100, 1
    s_lshl_b32 s90, s90, 14
    s_lshl_b32 s91, s59, 9
    s_add_u32 s90, s90, s91
    s_and_b32 s91, s100, 1
    s_lshl_b32 s91, s91, 8
    s_add_u32 s90, s90, s91
    s_add_u32 s95, s90, 3801088
    s_cmp_gt_i32 s89, 457
    s_cbranch_scc1 L_sk12
    s_waitcnt vmcnt(4)
L_sk12:
    s_waitcnt vmcnt(10)
    s_add_u32 s61, s61, 7168
    buffer_load_dwordx4 v[52:55], v13, s[16:19], s61 offen nt
    s_cmp_lg_u32 s3, 0
    s_cbranch_scc1 L_nos2
    s_waitcnt lgkmcnt(0)
    s_bfe_u32 s90, s96, 0x40000
    s_lshl_b32 s90, s90, 12
    s_and_b32 s91, s32, 0xfff
    s_or_b32 s98, s90, s91
    s_bfe_u32 s90, s96, 0x40004
    s_lshl_b32 s90, s90, 12
    s_and_b32 s91, s33, 0xfff
    s_or_b32 s99, s90, s91
    s_bfe_u32 s90, s96, 0x40008
    s_lshl_b32 s90, s90, 12
    s_and_b32 s91, s34, 0xfff
    s_or_b32 s92, s90, s91
    s_bfe_u32 s90, s96, 0x4000c
    s_lshl_b32 s90, s90, 12
    s_and_b32 s91, s35, 0xfff
    s_or_b32 s93, s90, s91
    s_waitcnt vmcnt(2)
    v_xor_b32 v27, s32, v216
    v_bitop3_b32 v27, v27, v217, s33 bitop3:0xf6
    v_bitop3_b32 v27, v27, v218, s34 bitop3:0xf6
    v_bitop3_b32 v27, v27, v219, s35 bitop3:0xf6
    v_bitop3_b32 v27, v27, v220, s32 bitop3:0xf6
    v_bitop3_b32 v27, v27, v221, s33 bitop3:0xf6
    v_bitop3_b32 v27, v27, v222, s34 bitop3:0xf6
    v_bitop3_b32 v27, v27, v223, s35 bitop3:0xf6
    v_and_b32 v27, 0xff, v27
    v_cmp_ne_u32 vcc, 0, v27
    s_cbranch_vccz L_ok13
L_retry13:
    s_wqm_b64 exec, vcc
    s_sleep 1
    buffer_load_dwordx4 v[216:219], v3, s[12:15], s94 offen offset:0 sc1
    buffer_load_dwordx4 v[220:223], v3, s[12:15], s94 offen offset:1024 sc1
    s_waitcnt vmcnt(0)
    v_xor_b32 v27, s32, v216
    v_bitop3_b32 v27, v27, v217, s33 bitop3:0xf6
    v_bitop3_b32 v27, v27, v218, s34 bitop3:0xf6
    v_bitop3_b32 v27, v27, v219, s35 bitop3:0xf6
    v_bitop3_b32 v27, v27, v220, s32 bitop3:0xf6
    v_bitop3_b32 v27, v27, v221, s33 bitop3:0xf6
    v_bitop3_b32 v27, v27, v222, s34 bitop3:0xf6
    v_bitop3_b32 v27, v27, v223, s35 bitop3:0xf6
    v_and_b32 v27, 0xff, v27
    v_cmp_ne_u32 vcc, 0, v27
    s_sub_u32 s58, s58, 1
    s_cbranch_scc1 L_giveup13
    s_cbranch_vccnz L_retry13
    s_branch L_fix13
L_giveup13:
    s_mov_b32 s58, 0
L_fix13:
    s_mov_b64 exec, -1
L_ok13:
    v_and_b32 v216, s52, v216
    v_and_b32 v217, s52, v217
    v_and_b32 v218, s52, v218
    v_and_b32 v219, s52, v219
    v_and_b32 v220, s52, v220
    v_and_b32 v221, s52, v221
    v_and_b32 v222, s52, v222
    v_and_b32 v223, s52, v223
    v_pk_add_f32 v[216:217], v[216:217], v[220:221]
    v_pk_add_f32 v[218:219], v[218:219], v[222:223]
    v_mov_b32 v220, v216
    v_mov_b32 v221, v217
    v_mov_b32 v222, v218
    v_mov_b32 v223, v219
    v_permlane16_swap_b32 v220, v216
    v_permlane16_swap_b32 v221, v217
    v_permlane16_swap_b32 v222, v218
    v_permlane16_swap_b32 v223, v219
    v_add_f32 v216, v216, v220
    v_add_f32 v217, v217, v221
    v_add_f32 v218, v218, v222
    v_add_f32 v219, v219, v223
    v_mov_b32 v220, v216
    v_mov_b32 v221, v217
    v_mov_b32 v222, v218
    v_mov_b32 v223, v219
    v_permlane32_swap_b32 v220, v216
    v_permlane32_swap_b32 v221, v217
    v_permlane32_swap_b32 v222, v218
    v_permlane32_swap_b32 v223, v219
    v_add_f32 v216, v216, v220
    v_add_f32 v217, v217, v221
    v_add_f32 v218, v218, v222
    v_add_f32 v219, v219, v223
    v_cvt_pk_bf16_f32 v28, v216, v217
    v_lshlrev_b32 v216, 16, v28
    v_and_b32 v217, s53, v28
    v_cvt_pk_bf16_f32 v28, v218, v219
    v_lshlrev_b32 v218, 16, v28
    v_and_b32 v219, s53, v28
    v_or_b32 v216, s98, v216
    v_or_b32 v217, s99, v217
    v_or_b32 v218, s92, v218
    v_or_b32 v219, s93, v219
    s_mov_b64 exec, 0xffff
    buffer_store_dwordx4 v[216:219], v3, s[28:31], s95 offen sc1
    s_mov_b64 exec, -1
    s_nop 1
L_nos2:
    s_cmp_eq_u32 s3, 1
    s_cselect_b32 s14, s30, 0
    s_lshl_b32 s90, s57, 12
    s_add_u32 s90, s90, 3866624
    v_lshrrev_b32 v31, 2, v0
    v_lshlrev_b32 v31, 7, v31
    v_and_b32 v30, 0x30, v3
    v_add_u32 v31, v31, v30
    buffer_load_dwordx4 v[120:123], v31, s[12:15], s90 offen nt
    buffer_load_dwordx4 v[124:127], v31, s[12:15], s90 offen offset:2048 nt
    s_waitcnt lgkmcnt(0)
    s_sub_u32 s89, s86, s88
    s_memrealtime s[86:87]
    s_cmp_gt_i32 s89, 486
    s_cbranch_scc1 L_sk14
    s_waitcnt vmcnt(6)
L_sk14:
    s_waitcnt vmcnt(11)
    s_add_u32 s61, s61, 7168
    buffer_load_dwordx4 v[56:59], v13, s[16:19], s61 offen nt
    s_cmp_gt_i32 s89, 515
    s_cbranch_scc1 L_sk15
    s_waitcnt vmcnt(4)
L_sk15:
    s_waitcnt vmcnt(11)
    s_add_u32 s61, s61, 7168
    buffer_load_dwordx4 v[60:63], v13, s[16:19], s61 offen nt
    s_cmp_gt_i32 s89, 544
    s_cbranch_scc1 L_sk16
    s_waitcnt vmcnt(4)
L_sk16:
    s_waitcnt vmcnt(11)
    s_add_u32 s44, s43, 98304
    s_add_u32 m0, s46, 12288
    s_nop 0
    buffer_load_dwordx4 v4, s[4:7], s44 offen offset:0 nt lds
    s_waitcnt lgkmcnt(0)
    s_sub_u32 s89, s86, s88
    s_memrealtime s[86:87]
    s_cmp_gt_i32 s89, 573
    s_cbranch_scc1 L_sk17
    s_waitcnt vmcnt(2)
L_sk17:
    s_waitcnt vmcnt(11)
    buffer_load_dwordx4 v5, s[4:7], s44 offen offset:1024 nt lds
    s_cmp_gt_i32 s89, 602
    s_cbranch_scc1 L_sk18
    s_waitcnt vmcnt(2)
L_sk18:
    s_waitcnt vmcnt(11)
    buffer_load_dwordx4 v6, s[4:7], s44 offen offset:2048 nt lds
    s_cmp_gt_i32 s89, 631
    s_cbranch_scc1 L_sk19
    s_waitcnt vmcnt(2)
L_sk19:
    s_waitcnt vmcnt(11)
    buffer_load_dwordx4 v7, s[4:7], s44 offen offset:3072 nt lds
    s_waitcnt lgkmcnt(0)
    s_sub_u32 s89, s86, s88
    s_memrealtime s[86:87]
    s_cmp_gt_i32 s89, 660
    s_cbranch_scc1 L_sk20
    s_waitcnt vmcnt(2)
L_sk20:
    s_waitcnt vmcnt(9)
    s_add_u32 s45, s43, 0
    buffer_load_dwordx4 v[128:131], v3, s[8:11], s45 offen offset:0 nt
    s_cmp_lg_u32 s3, 1
    s_cbranch_scc1 L_xc21
    s_waitcnt vmcnt(7)
    s_and_b32 s92, s32, 0xff
    s_or_b32 s92, s92, s101
    v_xor_b32 v31, s92, v120
    v_bitop3_b32 v31, v31, v124, s92 bitop3:0xf6
    s_and_b32 s92, s33, 0xff
    s_or_b32 s92, s92, s101
    v_bitop3_b32 v31, v31, v121, s92 bitop3:0xf6
    v_bitop3_b32 v31, v31, v125, s92 bitop3:0xf6
    s_and_b32 s92, s34, 0xff
    s_or_b32 s92, s92, s101
    v_bitop3_b32 v31, v31, v122, s92 bitop3:0xf6
    v_bitop3_b32 v31, v31, v126, s92 bitop3:0xf6
    s_and_b32 s92, s35, 0xff
    s_or_b32 s92, s92, s101
    v_bitop3_b32 v31, v31, v123, s92 bitop3:0xf6
    v_bitop3_b32 v31, v31, v127, s92 bitop3:0xf6
    v_cmp_ne_u32 vcc, 0, v31
    s_and_b32 s92, s56, 3
    s_lshl_b32 s92, s92, 2
    s_lshl_b32 s92, 0x000f000f, s92
    s_or_b32 s93, vcc_lo, vcc_hi
    s_and_b32 s92, s92, s93
    s_cbranch_scc1 L_xc21
    s_cmp_eq_u32 s93, 0
    s_cselect_b32 s92, 3, 1
    v_mov_b32 v31, 152344
    v_mov_b32 v30, s92
    ds_write_b32 v31, v30
L_xc21:
    v_mov_b32 v27, 152324
L_w22:
    ds_read_b32 v28, v27
    s_waitcnt lgkmcnt(0)
    v_readfirstlane_b32 s90, v28
    s_nop 0
    s_cmp_lt_u32 s90, 8
    s_cbranch_scc1 L_w22
    ds_read_b64 v[200:201], v250 offset:1024
    s_waitcnt vmcnt(5)
    s_waitcnt lgkmcnt(0)
    v_perm_b32 v204, v201, v200, v17
    v_perm_b32 v205, v201, v200, v18
    v_perm_b32 v206, v201, v200, v19
    v_perm_b32 v207, v201, v200, v20
    v_perm_b32 v208, v201, v200, v21
    v_perm_b32 v209, v201, v200, v22
    v_perm_b32 v210, v201, v200, v23
    v_perm_b32 v211, v201, v200, v24
    v_mfma_f32_16x16x16_bf16 v[212:215], v[48:49], v[204:205], 0
    v_mfma_f32_16x16x16_bf16 v[216:219], v[50:51], v[204:205], 0
    v_mfma_f32_16x16x16_bf16 v[212:215], v[52:53], v[206:207], v[212:215]
    v_mfma_f32_16x16x16_bf16 v[216:219], v[54:55], v[206:207], v[216:219]
    v_mfma_f32_16x16x16_bf16 v[212:215], v[56:57], v[208:209], v[212:215]
    v_mfma_f32_16x16x16_bf16 v[216:219], v[58:59], v[208:209], v[216:219]
    v_mfma_f32_16x16x16_bf16 v[212:215], v[60:61], v[210:211], v[212:215]
    v_mfma_f32_16x16x16_bf16 v[216:219], v[62:63], v[210:211], v[216:219]
    s_nop 6
    ds_write_b128 v248, v[212:215]
    ds_write_b128 v248, v[216:219] offset:1024
    v_mov_b32 v27, 152328
    v_mov_b32 v28, 1
    s_mov_b64 exec, 1
    ds_add_u32 v27, v28
    s_mov_b64 exec, -1
    s_waitcnt lgkmcnt(0)
    s_sub_u32 s89, s86, s88
    s_memrealtime s[86:87]
    s_cmp_gt_i32 s89, 689
    s_cbranch_scc1 L_sk23
    s_waitcnt vmcnt(2)
L_sk23:
    buffer_load_dwordx4 v[132:135], v3, s[8:11], s45 offen offset:1024 nt
    v_and_b32 v29, 31, v0
    v_lshlrev_b32 v240, 4, v29
    s_bfe_u32 s90, s47, 0x20004
    s_lshl_b32 s90, s90, 3
    s_add_u32 s90, s90, s3
    s_lshr_b32 s91, s47, 6
    s_lshl_b32 s91, s91, 5
    s_add_u32 s90, s90, s91
    s_lshl_b32 s90, s90, 9
    s_add_u32 s94, s90, 3801088
    buffer_load_dwordx4 v[224:227], v240, s[28:31], s94 offen sc1
    s_cmp_gt_i32 s89, 718
    s_cbranch_scc1 L_sk24
    s_waitcnt vmcnt(3)
L_sk24:
    buffer_load_dwordx4 v[136:139], v3, s[8:11], s45 offen offset:2048 nt
    v_bfe_u32 v30, v29, 2, 2
    v_lshlrev_b32 v30, 6, v30
    v_lshrrev_b32 v31, 4, v29
    v_lshl_add_u32 v30, v31, 3, v30
    v_and_b32 v31, 3, v29
    v_lshl_add_u32 v30, v31, 1, v30
    s_mul_i32 s90, s3, 272
    s_add_u32 s90, s90, 149504
    v_add_u32 v30, s90, v30
    s_waitcnt vmcnt(1)
    v_xor_b32 v27, s32, v224
    v_bitop3_b32 v27, v27, v225, s33 bitop3:0xf6
    v_bitop3_b32 v27, v27, v226, s34 bitop3:0xf6
    v_bitop3_b32 v27, v27, v227, s35 bitop3:0xf6
    v_and_b32 v27, 0xfff, v27
    v_cmp_ne_u32 vcc, 0, v27
    s_cbranch_vccz L_ok25
L_retry25:
    s_wqm_b64 exec, vcc
    s_sleep 1
    buffer_load_dwordx4 v[224:227], v240, s[28:31], s94 offen sc1
    s_waitcnt vmcnt(0)
    v_xor_b32 v27, s32, v224
    v_bitop3_b32 v27, v27, v225, s33 bitop3:0xf6
    v_bitop3_b32 v27, v27, v226, s34 bitop3:0xf6
    v_bitop3_b32 v27, v27, v227, s35 bitop3:0xf6
    v_and_b32 v27, 0xfff, v27
    v_cmp_ne_u32 vcc, 0, v27
    s_sub_u32 s58, s58, 1
    s_cbranch_scc1 L_giveup25
    s_cbranch_vccnz L_retry25
    s_branch L_fix25
L_giveup25:
    s_mov_b32 s58, 0
L_fix25:
    s_mov_b64 exec, -1
L_ok25:
    ds_write_b16_d16_hi v30, v224 offset:0
    ds_write_b16_d16_hi v30, v225 offset:16
    ds_write_b16_d16_hi v30, v226 offset:32
    ds_write_b16_d16_hi v30, v227 offset:48
    v_bfe_u32 v228, v224, 12, 4
    v_bfe_u32 v229, v225, 12, 4
    v_lshl_or_b32 v228, v229, 4, v228
    v_bfe_u32 v229, v226, 12, 4
    v_lshl_or_b32 v228, v229, 8, v228
    v_bfe_u32 v229, v227, 12, 4
    v_lshl_or_b32 v228, v229, 12, v228
    v_subrev_u32 v228, s88, v228
    v_bfe_i32 v228, v228, 0, 16
    v_mov_b32 v27, 152340
    s_mov_b64 exec, 0x10001
    ds_add_u32 v27, v228
    s_mov_b64 exec, -1
    v_mov_b32 v27, 152332
    v_mov_b32 v28, 1
    s_mov_b64 exec, 1
    ds_add_u32 v27, v28
    s_mov_b64 exec, -1
    buffer_load_dwordx4 v[140:143], v3, s[8:11], s45 offen offset:3072 nt
    s_add_u32 s45, s43, 32768
    buffer_load_dwordx4 v[144:147], v3, s[8:11], s45 offen offset:0 nt
    v_mov_b32 v27, 152328
L_w28:
    ds_read_b32 v28, v27
    s_waitcnt lgkmcnt(0)
    v_readfirstlane_b32 s90, v28
    s_nop 0
    s_cmp_lt_u32 s90, 8
    s_cbranch_scc1 L_w28
    v_mov_b32 v31, 152344
    ds_read_b32 v31, v31
    ds_read_b128 v[200:203], v249
    ds_read_b128 v[204:207], v249 offset:2048
    s_waitcnt lgkmcnt(0)
    v_pk_add_f32 v[200:201], v[200:201], v[204:205]
    v_pk_add_f32 v[202:203], v[202:203], v[206:207]
    v_mov_b32 v204, v200
    v_mov_b32 v205, v201
    v_mov_b32 v206, v202
    v_mov_b32 v207, v203
    v_permlane16_swap_b32 v204, v200
    v_permlane16_swap_b32 v205, v201
    v_permlane16_swap_b32 v206, v202
    v_permlane16_swap_b32 v207, v203
    v_add_f32 v200, v200, v204
    v_add_f32 v201, v201, v205
    v_add_f32 v202, v202, v206
    v_add_f32 v203, v203, v207
    v_mov_b32 v204, v200
    v_mov_b32 v205, v201
    v_mov_b32 v206, v202
    v_mov_b32 v207, v203
    v_permlane32_swap_b32 v204, v200
    v_permlane32_swap_b32 v205, v201
    v_permlane32_swap_b32 v206, v202
    v_permlane32_swap_b32 v207, v203
    v_add_f32 v200, v200, v204
    v_add_f32 v201, v201, v205
    v_add_f32 v202, v202, v206
    v_add_f32 v203, v203, v207
    v_readfirstlane_b32 s48, v31
    v_add_u32 v200, 0x80, v200
    v_bfi_b32 v200, v1, s32, v200
    v_add_u32 v201, 0x80, v201
    v_bfi_b32 v201, v1, s33, v201
    v_add_u32 v202, 0x80, v202
    v_bfi_b32 v202, v1, s34, v202
    v_add_u32 v203, 0x80, v203
    v_bfi_b32 v203, v1, s35, v203
    s_lshl_b32 s90, s47, 11
    s_lshl_b32 s91, s3, 8
    s_add_u32 s90, s90, s91
    s_add_u32 s90, s90, 589824
    s_mov_b64 exec, 0xffff
    s_bitcmp1_b32 s48, 0
    s_cbranch_scc1 L_ls29
    buffer_store_dwordx4 v[200:203], v3, s[28:31], s90 offen sc1
    s_branch L_le29
L_ls29:
    buffer_store_dwordx4 v[200:203], v3, s[28:31], s90 offen
L_le29:
    s_mov_b64 exec, -1
    s_waitcnt lgkmcnt(0)
    s_sub_u32 s89, s86, s88
    s_memrealtime s[86:87]
    s_cmp_gt_i32 s89, 805
    s_cbranch_scc1 L_sk30
    s_waitcnt vmcnt(3)
L_sk30:
    buffer_load_dwordx4 v[148:151], v3, s[8:11], s45 offen offset:1024 nt
    s_cmp_gt_i32 s89, 834
    s_cbranch_scc1 L_sk31
    s_waitcnt vmcnt(3)
L_sk31:
    buffer_load_dwordx4 v[152:155], v3, s[8:11], s45 offen offset:2048 nt
    v_and_b32 v29, 7, v0
    v_mul_u32_u24 v29, 272, v29
    v_lshrrev_b32 v30, 4, v0
    v_lshl_add_u32 v29, v30, 4, v29
    v_add_u32 v29, 149504, v29
    v_mov_b32 v27, 152332
L_w32:
    ds_read_b32 v28, v27
    s_waitcnt lgkmcnt(0)
    v_readfirstlane_b32 s90, v28
    s_nop 0
    s_cmp_lt_u32 s90, 8
    s_cbranch_scc1 L_w32
    ds_read_b128 v[80:83], v29 offset:0
    ds_read_b128 v[84:87], v29 offset:64
    ds_read_b128 v[88:91], v29 offset:128
    ds_read_b128 v[92:95], v29 offset:192
    v_mov_b32 v27, 152340
    ds_read_b32 v28, v27
    s_waitcnt lgkmcnt(0)
    v_readfirstlane_b32 s89, v28
    s_nop 0
    s_ashr_i32 s89, s89, 4
    s_add_u32 s88, s88, s89
    v_and_b32 v64, v80, v15
    v_and_b32 v80, v80, v16
    v_and_b32 v65, v81, v15
    v_and_b32 v81, v81, v16
    v_and_b32 v66, v82, v15
    v_and_b32 v82, v82, v16
    v_and_b32 v67, v83, v15
    v_and_b32 v83, v83, v16
    v_and_b32 v68, v84, v15
    v_and_b32 v84, v84, v16
    v_and_b32 v69, v85, v15
    v_and_b32 v85, v85, v16
    v_and_b32 v70, v86, v15
    v_and_b32 v86, v86, v16
    v_and_b32 v71, v87, v15
    v_and_b32 v87, v87, v16
    v_and_b32 v72, v88, v15
    v_and_b32 v88, v88, v16
    v_and_b32 v73, v89, v15
    v_and_b32 v89, v89, v16
    v_and_b32 v74, v90, v15
    v_and_b32 v90, v90, v16
    v_and_b32 v75, v91, v15
    v_and_b32 v91, v91, v16
    v_and_b32 v76, v92, v15
    v_and_b32 v92, v92, v16
    v_and_b32 v77, v93, v15
    v_and_b32 v93, v93, v16
    v_and_b32 v78, v94, v15
    v_and_b32 v94, v94, v16
    v_and_b32 v79, v95, v15
    v_and_b32 v95, v95, v16
    ds_read_b128 v[112:115], v8 offset:0
    ds_read_b128 v[116:119], v9 offset:0
    ds_read_b128 v[120:123], v10 offset:0
    ds_read_b128 v[124:127], v11 offset:0
    s_waitcnt lgkmcnt(3)
    v_mfma_f32_16x16x32_bf16 v[96:99], v[112:115], v[64:67], 0
    s_waitcnt lgkmcnt(2)
    v_mfma_f32_16x16x32_bf16 v[96:99], v[116:119], v[68:71], v[96:99]
    s_waitcnt lgkmcnt(1)
    v_mfma_f32_16x16x32_bf16 v[96:99], v[120:123], v[72:75], v[96:99]
    s_waitcnt lgkmcnt(0)
    v_mfma_f32_16x16x32_bf16 v[96:99], v[124:127], v[76:79], v[96:99]
    s_waitcnt lgkmcnt(0)
    s_sub_u32 s89, s86, s88
    s_memrealtime s[86:87]
    s_cmp_gt_i32 s89, 427
    s_cbranch_scc1 L_sk33
    s_waitcnt vmcnt(3)
L_sk33:
    buffer_load_dwordx4 v[156:159], v3, s[8:11], s45 offen offset:3072 nt
    s_cmp_gt_i32 s89, 456
    s_cbranch_scc1 L_sk34
    s_waitcnt vmcnt(2)
L_sk34:
    s_add_u32 s44, s43, 131072
    s_add_u32 m0, s46, 0
    s_nop 0
    buffer_load_dwordx4 v4, s[4:7], s44 offen offset:0 nt lds
    ds_read_b128 v[112:115], v8 offset:4096
    ds_read_b128 v[116:119], v9 offset:4096
    ds_read_b128 v[120:123], v10 offset:4096
    ds_read_b128 v[124:127], v11 offset:4096
    s_waitcnt lgkmcnt(3)
    v_mfma_f32_16x16x32_bf16 v[100:103], v[112:115], v[64:67], 0
    s_waitcnt lgkmcnt(2)
    v_mfma_f32_16x16x32_bf16 v[100:103], v[116:119], v[68:71], v[100:103]
    s_waitcnt lgkmcnt(1)
    v_mfma_f32_16x16x32_bf16 v[100:103], v[120:123], v[72:75], v[100:103]
    s_waitcnt lgkmcnt(0)
    v_mfma_f32_16x16x32_bf16 v[100:103], v[124:127], v[76:79], v[100:103]
    s_cmp_gt_i32 s89, 485
    s_cbranch_scc1 L_sk35
    s_waitcnt vmcnt(2)
L_sk35:
    buffer_load_dwordx4 v5, s[4:7], s44 offen offset:1024 nt lds
    s_waitcnt lgkmcnt(0)
    s_sub_u32 s89, s86, s88
    s_memrealtime s[86:87]
    s_cmp_gt_i32 s89, 514
    s_cbranch_scc1 L_sk36
    s_waitcnt vmcnt(2)
L_sk36:
    s_waitcnt vmcnt(8)
    buffer_load_dwordx4 v6, s[4:7], s44 offen offset:2048 nt lds
    ds_read_b128 v[112:115], v8 offset:8192
    ds_read_b128 v[116:119], v9 offset:8192
    ds_read_b128 v[120:123], v10 offset:8192
    ds_read_b128 v[124:127], v11 offset:8192
    s_waitcnt lgkmcnt(3)
    v_mfma_f32_16x16x32_bf16 v[96:99], v[112:115], v[80:83], v[96:99]
    s_waitcnt lgkmcnt(2)
    v_mfma_f32_16x16x32_bf16 v[96:99], v[116:119], v[84:87], v[96:99]
    s_waitcnt lgkmcnt(1)
    v_mfma_f32_16x16x32_bf16 v[96:99], v[120:123], v[88:91], v[96:99]
    s_waitcnt lgkmcnt(0)
    v_mfma_f32_16x16x32_bf16 v[96:99], v[124:127], v[92:95], v[96:99]
    s_cmp_gt_i32 s89, 543
    s_cbranch_scc1 L_sk37
    s_waitcnt vmcnt(2)
L_sk37:
    s_waitcnt vmcnt(8)
    buffer_load_dwordx4 v7, s[4:7], s44 offen offset:3072 nt lds
    s_cmp_gt_i32 s89, 572
    s_cbranch_scc1 L_sk38
    s_waitcnt vmcnt(2)
L_sk38:
    s_waitcnt vmcnt(8)
    s_add_u32 s44, s43, 163840
    s_add_u32 m0, s46, 4096
    s_nop 0
    buffer_load_dwordx4 v4, s[4:7], s44 offen offset:0 nt lds
    ds_read_b128 v[112:115], v8 offset:12288
    ds_read_b128 v[116:119], v9 offset:12288
    ds_read_b128 v[120:123], v10 offset:12288
    ds_read_b128 v[124:127], v11 offset:12288
    s_waitcnt lgkmcnt(3)
    v_mfma_f32_16x16x32_bf16 v[100:103], v[112:115], v[80:83], v[100:103]
    s_waitcnt lgkmcnt(2)
    v_mfma_f32_16x16x32_bf16 v[100:103], v[116:119], v[84:87], v[100:103]
    s_waitcnt lgkmcnt(1)
    v_mfma_f32_16x16x32_bf16 v[100:103], v[120:123], v[88:91], v[100:103]
    s_waitcnt lgkmcnt(0)
    v_mfma_f32_16x16x32_bf16 v[100:103], v[124:127], v[92:95], v[100:103]
    s_waitcnt lgkmcnt(0)
    s_sub_u32 s89, s86, s88
    s_memrealtime s[86:87]
    s_cmp_gt_i32 s89, 601
    s_cbranch_scc1 L_sk39
    s_waitcnt vmcnt(2)
L_sk39:
    s_waitcnt vmcnt(7)
    buffer_load_dwordx4 v5, s[4:7], s44 offen offset:1024 nt lds
    s_cmp_gt_i32 s89, 630
    s_cbranch_scc1 L_sk40
    s_waitcnt vmcnt(2)
L_sk40:
    s_waitcnt vmcnt(7)
    buffer_load_dwordx4 v6, s[4:7], s44 offen offset:2048 nt lds
    s_cmp_gt_i32 s89, 659
    s_cbranch_scc1 L_sk41
    s_waitcnt vmcnt(2)
L_sk41:
    s_waitcnt vmcnt(7)
    buffer_load_dwordx4 v7, s[4:7], s44 offen offset:3072 nt lds
    s_waitcnt lgkmcnt(0)
    s_sub_u32 s89, s86, s88
    s_memrealtime s[86:87]
    s_cmp_gt_i32 s89, 688
    s_cbranch_scc1 L_sk42
    s_waitcnt vmcnt(2)
L_sk42:
    s_waitcnt vmcnt(7)
    s_add_u32 s44, s43, 196608
    s_add_u32 m0, s46, 8192
    s_nop 0
    buffer_load_dwordx4 v4, s[4:7], s44 offen offset:0 nt lds
    s_waitcnt vmcnt(5)
    ds_read_b128 v[112:115], v8 offset:0
    ds_read_b128 v[116:119], v9 offset:0
    ds_read_b128 v[120:123], v10 offset:0
    ds_read_b128 v[124:127], v11 offset:0
    s_waitcnt lgkmcnt(3)
    v_mfma_f32_16x16x32_bf16 v[104:107], v[112:115], v[64:67], 0
    s_waitcnt lgkmcnt(2)
    v_mfma_f32_16x16x32_bf16 v[104:107], v[116:119], v[68:71], v[104:107]
    s_waitcnt lgkmcnt(1)
    v_mfma_f32_16x16x32_bf16 v[104:107], v[120:123], v[72:75], v[104:107]
    s_waitcnt lgkmcnt(0)
    v_mfma_f32_16x16x32_bf16 v[104:107], v[124:127], v[76:79], v[104:107]
    v_bfe_u32 v28, v0, 2, 2
    v_lshlrev_b32 v28, 12, v28
    v_lshrrev_b32 v29, 4, v0
    v_lshl_add_u32 v28, v29, 6, v28
    v_and_b32 v29, 3, v0
    v_lshl_add_u32 v248, v29, 4, v28
    s_lshl_b32 s94, s59, 14
    s_lshl_b32 s95, s3, 8
    s_add_u32 s94, s94, s95
    s_add_u32 s94, s94, 589824
    s_cmp_eq_u32 s3, s100
    s_cselect_b32 s14, s30, 0
    s_bitcmp1_b32 s48, 0
    s_cbranch_scc1 L_ls43
    buffer_load_dwordx4 v[240:243], v248, s[12:15], s94 offen offset:0 sc1
    buffer_load_dwordx4 v[244:247], v248, s[12:15], s94 offen offset:2048 sc1
    s_branch L_le43
L_ls43:
    buffer_load_dwordx4 v[240:243], v248, s[12:15], s94 offen offset:0 nt
    buffer_load_dwordx4 v[244:247], v248, s[12:15], s94 offen offset:2048 nt
L_le43:
    s_waitcnt lgkmcnt(0)
    s_sub_u32 s89, s86, s88
    s_memrealtime s[86:87]
    s_cmp_gt_i32 s89, 717
    s_cbranch_scc1 L_sk44
    s_waitcnt vmcnt(4)
L_sk44:
    buffer_load_dwordx4 v5, s[4:7], s44 offen offset:1024 nt lds
    s_cmp_gt_i32 s89, 746
    s_cbranch_scc1 L_sk45
    s_waitcnt vmcnt(4)
L_sk45:
    buffer_load_dwordx4 v6, s[4:7], s44 offen offset:2048 nt lds
    s_cmp_gt_i32 s89, 775
    s_cbranch_scc1 L_sk46
    s_waitcnt vmcnt(4)
L_sk46:
    buffer_load_dwordx4 v7, s[4:7], s44 offen offset:3072 nt lds
    s_waitcnt lgkmcnt(0)
    s_sub_u32 s89, s86, s88
    s_memrealtime s[86:87]
    s_cmp_gt_i32 s89, 804
    s_cbranch_scc1 L_sk47
    s_waitcnt vmcnt(2)
L_sk47:
    s_waitcnt vmcnt(9)
    s_add_u32 s44, s43, 229376
    s_add_u32 m0, s46, 12288
    s_nop 0
    buffer_load_dwordx4 v4, s[4:7], s44 offen offset:0 nt lds
    s_waitcnt vmcnt(7)
    ds_read_b128 v[112:115], v8 offset:4096
    ds_read_b128 v[116:119], v9 offset:4096
    ds_read_b128 v[120:123], v10 offset:4096
    ds_read_b128 v[124:127], v11 offset:4096
    s_waitcnt lgkmcnt(3)
    v_mfma_f32_16x16x32_bf16 v[108:111], v[112:115], v[64:67], 0
    s_waitcnt lgkmcnt(2)
    v_mfma_f32_16x16x32_bf16 v[108:111], v[116:119], v[68:71], v[108:111]
    s_waitcnt lgkmcnt(1)
    v_mfma_f32_16x16x32_bf16 v[108:111], v[120:123], v[72:75], v[108:111]
    s_waitcnt lgkmcnt(0)
    v_mfma_f32_16x16x32_bf16 v[108:111], v[124:127], v[76:79], v[108:111]
    s_cmp_gt_i32 s89, 833
    s_cbranch_scc1 L_sk48
    s_waitcnt vmcnt(2)
L_sk48:
    buffer_load_dwordx4 v5, s[4:7], s44 offen offset:1024 nt lds
    s_cmp_gt_i32 s89, 862
    s_cbranch_scc1 L_sk49
    s_waitcnt vmcnt(2)
L_sk49:
    buffer_load_dwordx4 v6, s[4:7], s44 offen offset:2048 nt lds
    s_waitcnt lgkmcnt(0)
    s_sub_u32 s89, s86, s88
    s_memrealtime s[86:87]
    s_cmp_gt_i32 s89, 891
    s_cbranch_scc1 L_sk50
    s_waitcnt vmcnt(2)
L_sk50:
    buffer_load_dwordx4 v7, s[4:7], s44 offen offset:3072 nt lds
    s_cmp_gt_i32 s89, 920
    s_cbranch_scc1 L_sk51
    s_waitcnt vmcnt(2)
L_sk51:
    s_waitcnt vmcnt(9)
    s_add_u32 s45, s43, 65536
    buffer_load_dwordx4 v[160:163], v3, s[8:11], s45 offen offset:0 nt
    s_waitcnt vmcnt(5)
    ds_read_b128 v[112:115], v8 offset:8192
    ds_read_b128 v[116:119], v9 offset:8192
    ds_read_b128 v[120:123], v10 offset:8192
    ds_read_b128 v[124:127], v11 offset:8192
    s_waitcnt lgkmcnt(3)
    v_mfma_f32_16x16x32_bf16 v[104:107], v[112:115], v[80:83], v[104:107]
    s_waitcnt lgkmcnt(2)
    v_mfma_f32_16x16x32_bf16 v[104:107], v[116:119], v[84:87], v[104:107]
    s_waitcnt lgkmcnt(1)
    v_mfma_f32_16x16x32_bf16 v[104:107], v[120:123], v[88:91], v[104:107]
    s_waitcnt lgkmcnt(0)
    v_mfma_f32_16x16x32_bf16 v[104:107], v[124:127], v[92:95], v[104:107]
    s_cmp_lg_u32 s3, s100
    s_cbranch_scc1 L_noh
    v_xor_b32 v27, s32, v240
    v_bitop3_b32 v27, v27, v241, s33 bitop3:0xf6
    v_bitop3_b32 v27, v27, v242, s34 bitop3:0xf6
    v_bitop3_b32 v27, v27, v243, s35 bitop3:0xf6
    v_bitop3_b32 v27, v27, v244, s32 bitop3:0xf6
    v_bitop3_b32 v27, v27, v245, s33 bitop3:0xf6
    v_bitop3_b32 v27, v27, v246, s34 bitop3:0xf6
    v_bitop3_b32 v27, v27, v247, s35 bitop3:0xf6
    v_and_b32 v27, 0xff, v27
    v_cmp_ne_u32 vcc, 0, v27
    s_cbranch_vccz L_ok52
L_retry52:
    s_wqm_b64 exec, vcc
    s_sleep 1
    buffer_load_dwordx4 v[240:243], v248, s[12:15], s94 offen offset:0 sc1
    buffer_load_dwordx4 v[244:247], v248, s[12:15], s94 offen offset:2048 sc1
    s_waitcnt vmcnt(0)
    v_xor_b32 v27, s32, v240
    v_bitop3_b32 v27, v27, v241, s33 bitop3:0xf6
    v_bitop3_b32 v27, v27, v242, s34 bitop3:0xf6
    v_bitop3_b32 v27, v27, v243, s35 bitop3:0xf6
    v_bitop3_b32 v27, v27, v244, s32 bitop3:0xf6
    v_bitop3_b32 v27, v27, v245, s33 bitop3:0xf6
    v_bitop3_b32 v27, v27, v246, s34 bitop3:0xf6
    v_bitop3_b32 v27, v27, v247, s35 bitop3:0xf6
    v_and_b32 v27, 0xff, v27
    v_cmp_ne_u32 vcc, 0, v27
    s_sub_u32 s58, s58, 1
    s_cbranch_scc1 L_giveup52
    s_cbranch_vccnz L_retry52
    s_branch L_fix52
L_giveup52:
    s_mov_b32 s58, 0
L_fix52:
    s_mov_b64 exec, -1
L_ok52:
    v_and_b32 v240, s52, v240
    v_and_b32 v241, s52, v241
    v_and_b32 v242, s52, v242
    v_and_b32 v243, s52, v243
    v_and_b32 v244, s52, v244
    v_and_b32 v245, s52, v245
    v_and_b32 v246, s52, v246
    v_and_b32 v247, s52, v247
    v_add_f32 v240, v240, v244
    v_add_f32 v241, v241, v245
    v_add_f32 v242, v242, v246
    v_add_f32 v243, v243, v247
    v_add_f32_dpp v240, v240, v240 row_ror:4 row_mask:0xf bank_mask:0xf
    v_add_f32_dpp v241, v241, v241 row_ror:4 row_mask:0xf bank_mask:0xf
    v_add_f32_dpp v242, v242, v242 row_ror:4 row_mask:0xf bank_mask:0xf
    v_add_f32_dpp v243, v243, v243 row_ror:4 row_mask:0xf bank_mask:0xf
    v_add_f32_dpp v240, v240, v240 row_ror:8 row_mask:0xf bank_mask:0xf
    v_add_f32_dpp v241, v241, v241 row_ror:8 row_mask:0xf bank_mask:0xf
    v_add_f32_dpp v242, v242, v242 row_ror:8 row_mask:0xf bank_mask:0xf
    v_add_f32_dpp v243, v243, v243 row_ror:8 row_mask:0xf bank_mask:0xf
    v_cvt_pk_bf16_f32 v28, v240, v241
    v_lshlrev_b32 v240, 16, v28
    v_and_b32 v241, s53, v28
    v_cvt_pk_bf16_f32 v28, v242, v243
    v_lshlrev_b32 v242, 16, v28
    v_and_b32 v243, s53, v28
    v_lshlrev_b32 v252, 16, v252
    v_add_f32 v240, v240, v252
    v_lshlrev_b32 v253, 16, v253
    v_add_f32 v241, v241, v253
    v_lshlrev_b32 v254, 16, v254
    v_add_f32 v242, v242, v254
    v_lshlrev_b32 v255, 16, v255
    v_add_f32 v243, v243, v255
    v_cvt_pk_bf16_f32 v28, v240, v241
    v_lshlrev_b32 v240, 16, v28
    v_and_b32 v241, s53, v28
    v_cvt_pk_bf16_f32 v28, v242, v243
    v_lshlrev_b32 v242, 16, v28
    v_and_b32 v243, s53, v28
    v_mul_f32 v244, v240, v240
    v_mul_f32 v244, 0x3d372713, v244
    v_fma_f32 v244, v244, v240, v240
    v_mul_f32 v244, 0xc0135761, v244
    v_mul_f32 v245, v241, v241
    v_mul_f32 v245, 0x3d372713, v245
    v_fma_f32 v245, v245, v241, v241
    v_mul_f32 v245, 0xc0135761, v245
    v_mul_f32 v246, v242, v242
    v_mul_f32 v246, 0x3d372713, v246
    v_fma_f32 v246, v246, v242, v242
    v_mul_f32 v246, 0xc0135761, v246
    v_mul_f32 v247, v243, v243
    v_mul_f32 v247, 0x3d372713, v247
    v_fma_f32 v247, v247, v243, v243
    v_mul_f32 v247, 0xc0135761, v247
    v_exp_f32 v244, v244
    v_exp_f32 v245, v245
    v_exp_f32 v246, v246
    v_exp_f32 v247, v247
    v_add_f32 v244, 1.0, v244
    v_add_f32 v245, 1.0, v245
    v_add_f32 v246, 1.0, v246
    v_add_f32 v247, 1.0, v247
    v_rcp_f32 v244, v244
    v_rcp_f32 v245, v245
    v_rcp_f32 v246, v246
    v_rcp_f32 v247, v247
    v_mul_f32 v240, v240, v244
    v_mul_f32 v241, v241, v245
    v_mul_f32 v242, v242, v246
    v_mul_f32 v243, v243, v247
    v_cvt_pk_bf16_f32 v28, v240, v241
    v_lshlrev_b32 v240, 16, v28
    v_and_b32 v241, s53, v28
    v_cvt_pk_bf16_f32 v28, v242, v243
    v_lshlrev_b32 v242, 16, v28
    v_and_b32 v243, s53, v28
    v_or_b32 v240, s32, v240
    v_or_b32 v241, s33, v241
    v_or_b32 v242, s34, v242
    v_or_b32 v243, s35, v243
    v_and_b32 v248, 0xfff, v248
    s_lshl_b32 s90, s47, 8
    s_add_u32 s90, s90, 3407872
    s_mov_b32 exec_lo, 0x000f000f
    s_mov_b32 exec_hi, 0x000f000f
    buffer_store_dwordx4 v[240:243], v248, s[28:31], s90 offen sc1
    s_mov_b64 exec, -1
    s_nop 1
L_noh:
    s_waitcnt lgkmcnt(0)
    s_sub_u32 s89, s86, s88
    s_memrealtime s[86:87]
    s_cmp_gt_i32 s89, 949
    s_cbranch_scc1 L_sk53
    s_waitcnt vmcnt(2)
L_sk53:
    buffer_load_dwordx4 v[164:167], v3, s[8:11], s45 offen offset:1024 nt
    s_cmp_gt_i32 s89, 978
    s_cbranch_scc1 L_sk54
    s_waitcnt vmcnt(2)
L_sk54:
    buffer_load_dwordx4 v[168:171], v3, s[8:11], s45 offen offset:2048 nt
    s_waitcnt vmcnt(3)
    ds_read_b128 v[112:115], v8 offset:12288
    ds_read_b128 v[116:119], v9 offset:12288
    ds_read_b128 v[120:123], v10 offset:12288
    ds_read_b128 v[124:127], v11 offset:12288
    s_waitcnt lgkmcnt(3)
    v_mfma_f32_16x16x32_bf16 v[108:111], v[112:115], v[80:83], v[108:111]
    s_waitcnt lgkmcnt(2)
    v_mfma_f32_16x16x32_bf16 v[108:111], v[116:119], v[84:87], v[108:111]
    s_waitcnt lgkmcnt(1)
    v_mfma_f32_16x16x32_bf16 v[108:111], v[120:123], v[88:91], v[108:111]
    s_waitcnt lgkmcnt(0)
    v_mfma_f32_16x16x32_bf16 v[108:111], v[124:127], v[92:95], v[108:111]
    s_cmp_gt_i32 s89, 1007
    s_cbranch_scc1 L_sk55
    s_waitcnt vmcnt(2)
L_sk55:
    buffer_load_dwordx4 v[172:175], v3, s[8:11], s45 offen offset:3072 nt
    v_cvt_pk_bf16_f32 v28, v96, v97
    v_lshlrev_b32 v96, 16, v28
    v_and_b32 v97, s53, v28
    v_mul_f32 v96, s54, v96
    v_mul_f32 v97, s54, v97
    v_cvt_pk_bf16_f32 v28, v96, v97
    v_lshlrev_b32 v96, 16, v28
    v_and_b32 v97, s53, v28
    v_cvt_pk_bf16_f32 v28, v98, v99
    v_lshlrev_b32 v98, 16, v28
    v_and_b32 v99, s53, v28
    v_mul_f32 v98, s54, v98
    v_mul_f32 v99, s54, v99
    v_cvt_pk_bf16_f32 v28, v98, v99
    v_lshlrev_b32 v98, 16, v28
    v_and_b32 v99, s53, v28
    v_cvt_pk_bf16_f32 v28, v100, v101
    v_lshlrev_b32 v100, 16, v28
    v_and_b32 v101, s53, v28
    v_mul_f32 v100, s54, v100
    v_mul_f32 v101, s54, v101
    v_cvt_pk_bf16_f32 v28, v100, v101
    v_lshlrev_b32 v100, 16, v28
    v_and_b32 v101, s53, v28
    v_cvt_pk_bf16_f32 v28, v102, v103
    v_lshlrev_b32 v102, 16, v28
    v_and_b32 v103, s53, v28
    v_mul_f32 v102, s54, v102
    v_mul_f32 v103, s54, v103
    v_cvt_pk_bf16_f32 v28, v102, v103
    v_lshlrev_b32 v102, 16, v28
    v_and_b32 v103, s53, v28
    v_cvt_pk_bf16_f32 v28, v104, v105
    v_lshlrev_b32 v104, 16, v28
    v_and_b32 v105, s53, v28
    v_mul_f32 v104, s54, v104
    v_mul_f32 v105, s54, v105
    v_cvt_pk_bf16_f32 v28, v104, v105
    v_lshlrev_b32 v104, 16, v28
    v_and_b32 v105, s53, v28
    v_cvt_pk_bf16_f32 v28, v106, v107
    v_lshlrev_b32 v106, 16, v28
    v_and_b32 v107, s53, v28
    v_mul_f32 v106, s54, v106
    v_mul_f32 v107, s54, v107
    v_cvt_pk_bf16_f32 v28, v106, v107
    v_lshlrev_b32 v106, 16, v28
    v_and_b32 v107, s53, v28
    v_cvt_pk_bf16_f32 v28, v108, v109
    v_lshlrev_b32 v108, 16, v28
    v_and_b32 v109, s53, v28
    v_mul_f32 v108, s54, v108
    v_mul_f32 v109, s54, v109
    v_cvt_pk_bf16_f32 v28, v108, v109
    v_lshlrev_b32 v108, 16, v28
    v_and_b32 v109, s53, v28
    v_cvt_pk_bf16_f32 v28, v110, v111
    v_lshlrev_b32 v110, 16, v28
    v_and_b32 v111, s53, v28
    v_mul_f32 v110, s54, v110
    v_mul_f32 v111, s54, v111
    v_cvt_pk_bf16_f32 v28, v110, v111
    v_lshlrev_b32 v110, 16, v28
    v_and_b32 v111, s53, v28
    s_waitcnt lgkmcnt(0)
    s_sub_u32 s89, s86, s88
    s_memrealtime s[86:87]
    s_cmp_gt_i32 s89, 1036
    s_cbranch_scc1 L_sk56
    s_waitcnt vmcnt(2)
L_sk56:
    s_add_u32 s45, s43, 98304
    buffer_load_dwordx4 v[176:179], v3, s[8:11], s45 offen offset:0 nt
    v_max3_f32 v4, v96, v97, v98
    v_max3_f32 v4, v4, v99, v100
    v_max3_f32 v4, v4, v101, v102
    v_max3_f32 v4, v4, v103, v104
    v_max3_f32 v4, v4, v105, v106
    v_max3_f32 v4, v4, v107, v108
    v_max3_f32 v4, v4, v109, v110
    v_max_f32 v4, v4, v111
    s_nop 1
    v_max_f32_dpp v4, v4, v4 row_ror:8 row_mask:0xf bank_mask:0xf
    v_mov_b32 v28, v4
    s_nop 1
    v_permlane16_swap_b32 v28, v4
    v_max_f32 v4, v4, v28
    v_mov_b32 v28, v4
    s_nop 1
    v_permlane32_swap_b32 v28, v4
    v_max_f32 v4, v4, v28
    v_sub_f32 v112, 0, v4
    v_sub_f32 v113, 0, v4
    v_mov_b32 v114, s55
    v_mov_b32 v115, s55
    v_pk_add_f32 v[96:97], v[96:97], v[112:113]
    v_pk_add_f32 v[98:99], v[98:99], v[112:113]
    v_pk_add_f32 v[100:101], v[100:101], v[112:113]
    v_pk_add_f32 v[102:103], v[102:103], v[112:113]
    v_pk_add_f32 v[104:105], v[104:105], v[112:113]
    v_pk_add_f32 v[106:107], v[106:107], v[112:113]
    v_pk_add_f32 v[108:109], v[108:109], v[112:113]
    v_pk_add_f32 v[110:111], v[110:111], v[112:113]
    v_pk_mul_f32 v[96:97], v[96:97], v[114:115]
    v_pk_mul_f32 v[98:99], v[98:99], v[114:115]
    v_pk_mul_f32 v[100:101], v[100:101], v[114:115]
    v_pk_mul_f32 v[102:103], v[102:103], v[114:115]
    v_pk_mul_f32 v[104:105], v[104:105], v[114:115]
    v_pk_mul_f32 v[106:107], v[106:107], v[114:115]
    v_pk_mul_f32 v[108:109], v[108:109], v[114:115]
    v_pk_mul_f32 v[110:111], v[110:111], v[114:115]
    v_exp_f32 v96, v96
    v_exp_f32 v97, v97
    v_exp_f32 v98, v98
    v_exp_f32 v99, v99
    v_exp_f32 v100, v100
    v_exp_f32 v101, v101
    v_exp_f32 v102, v102
    v_exp_f32 v103, v103
    v_exp_f32 v104, v104
    v_exp_f32 v105, v105
    v_exp_f32 v106, v106
    v_exp_f32 v107, v107
    v_exp_f32 v108, v108
    v_exp_f32 v109, v109
    v_exp_f32 v110, v110
    v_exp_f32 v111, v111
    s_waitcnt lgkmcnt(0)
    s_sub_u32 s89, s86, s88
    s_memrealtime s[86:87]
    s_cmp_gt_i32 s89, 1065
    s_cbranch_scc1 L_sk57
    s_waitcnt vmcnt(2)
L_sk57:
    buffer_load_dwordx4 v[180:183], v3, s[8:11], s45 offen offset:1024 nt
    v_pk_add_f32 v[112:113], v[96:97], v[98:99]
    v_pk_add_f32 v[114:115], v[100:101], v[102:103]
    v_pk_add_f32 v[116:117], v[104:105], v[106:107]
    v_pk_add_f32 v[118:119], v[108:109], v[110:111]
    v_pk_add_f32 v[112:113], v[112:113], v[114:115]
    v_pk_add_f32 v[116:117], v[116:117], v[118:119]
    v_pk_add_f32 v[112:113], v[112:113], v[116:117]
    v_add_f32 v5, v112, v113
    s_nop 1
    v_add_f32_dpp v5, v5, v5 row_ror:8 row_mask:0xf bank_mask:0xf
    v_mov_b32 v28, v5
    s_nop 1
    v_permlane16_swap_b32 v28, v5
    v_add_f32 v5, v5, v28
    v_mov_b32 v28, v5
    s_nop 1
    v_permlane32_swap_b32 v28, v5
    v_add_f32 v5, v5, v28
    v_and_b32 v27, 7, v0
    v_lshlrev_b32 v27, 3, v27
    s_lshl_b32 s90, s3, 6
    s_add_u32 s90, s90, 151808
    v_add_u32 v27, s90, v27
    ds_write_b64 v27, v[4:5]
    v_mov_b32 v27, 152320
    v_mov_b32 v28, 1
    s_mov_b64 exec, 1
    ds_add_rtn_u32 v28, v27, v28
    s_mov_b64 exec, -1
    s_waitcnt lgkmcnt(0)
    v_readfirstlane_b32 s90, v28
    s_nop 0
    s_cmp_lg_u32 s90, 7
    s_cbranch_scc1 L_noagg
    v_lshlrev_b32 v27, 3, v0
    v_add_u32 v27, 151808, v27
    ds_read_b64 v[112:113], v27
    s_waitcnt lgkmcnt(0)
    v_mov_b32 v114, v112
    s_nop 1
    v_max_f32_dpp v114, v114, v114 row_ror:8 row_mask:0xf bank_mask:0xf
    v_mov_b32 v28, v114
    s_nop 1
    v_permlane16_swap_b32 v28, v114
    v_max_f32 v114, v114, v28
    v_mov_b32 v28, v114
    s_nop 1
    v_permlane32_swap_b32 v28, v114
    v_max_f32 v114, v114, v28
    v_sub_f32 v112, v112, v114
    v_mul_f32 v112, s55, v112
    v_exp_f32 v112, v112
    s_nop 0
    v_mul_f32 v115, v112, v113
    s_nop 1
    v_add_f32_dpp v115, v115, v115 row_ror:8 row_mask:0xf bank_mask:0xf
    v_mov_b32 v28, v115
    s_nop 1
    v_permlane16_swap_b32 v28, v115
    v_add_f32 v115, v115, v28
    v_mov_b32 v28, v115
    s_nop 1
    v_permlane32_swap_b32 v28, v115
    v_add_f32 v115, v115, v28
    v_mov_b32 v112, v114
    v_mov_b32 v113, v115
    v_bfi_b32 v112, v1, s32, v112
    v_bfi_b32 v113, v1, s33, v113
    v_bfi_b32 v114, v1, s34, v114
    v_bfi_b32 v115, v1, s35, v115
    s_lshl_b32 s90, s47, 7
    s_add_u32 s90, s90, 1114112
    s_mov_b64 exec, 0xff
    buffer_store_dwordx4 v[112:115], v3, s[28:31], s90 offen sc1
    s_mov_b64 exec, -1
    s_nop 1
L_noagg:
    s_waitcnt lgkmcnt(0)
    s_sub_u32 s89, s86, s88
    s_memrealtime s[86:87]
    s_cmp_gt_i32 s89, 1094
    s_cbranch_scc1 L_sk58
    s_waitcnt vmcnt(2)
L_sk58:
    buffer_load_dwordx4 v[184:187], v3, s[8:11], s45 offen offset:2048 nt
    v_cvt_pk_bf16_f32 v112, v96, v97
    v_cvt_pk_bf16_f32 v113, v98, v99
    v_cvt_pk_bf16_f32 v114, v100, v101
    v_cvt_pk_bf16_f32 v115, v102, v103
    v_cvt_pk_bf16_f32 v116, v104, v105
    v_cvt_pk_bf16_f32 v117, v106, v107
    v_cvt_pk_bf16_f32 v118, v108, v109
    v_cvt_pk_bf16_f32 v119, v110, v111
    v_and_b32 v64, v112, v15
    v_and_b32_dpp v68, v112, v16 row_ror:8 row_mask:0xf bank_mask:0xf
    v_and_b32_dpp v72, v112, v15 row_ror:8 row_mask:0xf bank_mask:0xf
    v_and_b32 v76, v112, v16
    v_and_b32 v65, v113, v15
    v_and_b32_dpp v69, v113, v16 row_ror:8 row_mask:0xf bank_mask:0xf
    v_and_b32_dpp v73, v113, v15 row_ror:8 row_mask:0xf bank_mask:0xf
    v_and_b32 v77, v113, v16
    v_and_b32 v66, v114, v15
    v_and_b32_dpp v70, v114, v16 row_ror:8 row_mask:0xf bank_mask:0xf
    v_and_b32_dpp v74, v114, v15 row_ror:8 row_mask:0xf bank_mask:0xf
    v_and_b32 v78, v114, v16
    v_and_b32 v67, v115, v15
    v_and_b32_dpp v71, v115, v16 row_ror:8 row_mask:0xf bank_mask:0xf
    v_and_b32_dpp v75, v115, v15 row_ror:8 row_mask:0xf bank_mask:0xf
    v_and_b32 v79, v115, v16
    v_and_b32 v80, v116, v15
    v_and_b32_dpp v84, v116, v16 row_ror:8 row_mask:0xf bank_mask:0xf
    v_and_b32_dpp v88, v116, v15 row_ror:8 row_mask:0xf bank_mask:0xf
    v_and_b32 v92, v116, v16
    v_and_b32 v81, v117, v15
    v_and_b32_dpp v85, v117, v16 row_ror:8 row_mask:0xf bank_mask:0xf
    v_and_b32_dpp v89, v117, v15 row_ror:8 row_mask:0xf bank_mask:0xf
    v_and_b32 v93, v117, v16
    v_and_b32 v82, v118, v15
    v_and_b32_dpp v86, v118, v16 row_ror:8 row_mask:0xf bank_mask:0xf
    v_and_b32_dpp v90, v118, v15 row_ror:8 row_mask:0xf bank_mask:0xf
    v_and_b32 v94, v118, v16
    v_and_b32 v83, v119, v15
    v_and_b32_dpp v87, v119, v16 row_ror:8 row_mask:0xf bank_mask:0xf
    v_and_b32_dpp v91, v119, v15 row_ror:8 row_mask:0xf bank_mask:0xf
    v_and_b32 v95, v119, v16
    s_waitcnt lgkmcnt(0)
    s_sub_u32 s89, s86, s88
    s_memrealtime s[86:87]
    s_cmp_gt_i32 s89, 1123
    s_cbranch_scc1 L_sk59
    s_waitcnt vmcnt(2)
L_sk59:
    buffer_load_dwordx4 v[188:191], v3, s[8:11], s45 offen offset:3072 nt
    s_cmp_gt_i32 s89, 1152
    s_cbranch_scc1 L_sk60
    s_waitcnt vmcnt(2)
L_sk60:
    s_waitcnt vmcnt(7)
    s_add_u32 s45, s43, 131072
    buffer_load_dwordx4 v[192:195], v3, s[8:11], s45 offen offset:0 nt
    v_add_u32 v9, s46, v3
    v_and_b32 v27, 7, v0
    v_mul_u32_u24 v27, 528, v27
    v_bfe_u32 v28, v0, 3, 1
    v_lshl_add_u32 v27, v28, 6, v27
    v_lshrrev_b32 v30, 4, v0
    v_lshl_add_u32 v27, v30, 4, v27
    v_add_u32 v6, s46, v27
    v_and_b32 v27, 0x1f0, v3
    v_lshrrev_b32 v28, 5, v0
    v_lshl_add_u32 v27, v28, 16, v27
    s_mul_i32 s90, s3, 528
    v_add_u32 v7, s90, v27
    v_and_b32 v27, 0xf0, v3
    v_lshl_add_u32 v28, v30, 15, v27
    s_lshl_b32 s90, s3, 8
    v_add_u32 v10, s90, v28
    v_lshlrev_b32 v29, 14, v30
    v_bfe_u32 v28, v0, 2, 1
    v_lshl_add_u32 v29, v28, 16, v29
    v_and_b32 v27, 3, v0
    v_lshl_add_u32 v8, v27, 4, v29
    v_lshlrev_b32 v27, 6, v27
    v_lshl_add_u32 v15, v30, 2, v27
    v_lshrrev_b32 v29, 3, v0
    v_lshlrev_b32 v29, 12, v29
    v_and_b32 v27, 0x70, v3
    v_add_u32 v16, v27, v29
    v_lshrrev_b32 v29, 2, v0
    v_lshlrev_b32 v29, 11, v29
    v_and_b32 v27, 0x30, v3
    v_add_u32 v11, v27, v29
    v_lshlrev_b32 v25, 16, v25
    v_lshlrev_b32 v26, 16, v26
    v_add_f32 v25, v25, v26
    v_perm_b32 v112, v132, v128, s50
    v_perm_b32 v116, v132, v128, s51
    v_perm_b32 v113, v140, v136, s50
    v_perm_b32 v117, v140, v136, s51
    v_perm_b32 v114, v148, v144, s50
    v_perm_b32 v118, v148, v144, s51
    v_perm_b32 v115, v156, v152, s50
    v_perm_b32 v119, v156, v152, s51
    s_nop 0
    v_mfma_f32_16x16x32_bf16 v[96:99], v[112:115], v[64:67], 0
    v_mfma_f32_16x16x32_bf16 v[96:99], v[116:119], v[68:71], v[96:99]
    v_perm_b32 v120, v133, v129, s50
    v_perm_b32 v124, v133, v129, s51
    v_perm_b32 v121, v141, v137, s50
    v_perm_b32 v125, v141, v137, s51
    v_perm_b32 v122, v149, v145, s50
    v_perm_b32 v126, v149, v145, s51
    v_perm_b32 v123, v157, v153, s50
    v_perm_b32 v127, v157, v153, s51
    s_nop 0
    v_mfma_f32_16x16x32_bf16 v[100:103], v[120:123], v[64:67], 0
    v_mfma_f32_16x16x32_bf16 v[100:103], v[124:127], v[68:71], v[100:103]
    s_waitcnt lgkmcnt(0)
    s_sub_u32 s89, s86, s88
    s_memrealtime s[86:87]
    s_cmp_gt_i32 s89, 1181
    s_cbranch_scc1 L_sk61
    s_waitcnt vmcnt(2)
L_sk61:
    s_waitcnt vmcnt(7)
    buffer_load_dwordx4 v[196:199], v3, s[8:11], s45 offen offset:1024 nt
    v_perm_b32 v112, v134, v130, s50
    v_perm_b32 v116, v134, v130, s51
    v_perm_b32 v113, v142, v138, s50
    v_perm_b32 v117, v142, v138, s51
    v_perm_b32 v114, v150, v146, s50
    v_perm_b32 v118, v150, v146, s51
    v_perm_b32 v115, v158, v154, s50
    v_perm_b32 v119, v158, v154, s51
    s_nop 0
    v_mfma_f32_16x16x32_bf16 v[104:107], v[112:115], v[64:67], 0
    v_mfma_f32_16x16x32_bf16 v[104:107], v[116:119], v[68:71], v[104:107]
    v_perm_b32 v120, v135, v131, s50
    v_perm_b32 v124, v135, v131, s51
    v_perm_b32 v121, v143, v139, s50
    v_perm_b32 v125, v143, v139, s51
    v_perm_b32 v122, v151, v147, s50
    v_perm_b32 v126, v151, v147, s51
    v_perm_b32 v123, v159, v155, s50
    v_perm_b32 v127, v159, v155, s51
    s_nop 0
    v_mfma_f32_16x16x32_bf16 v[108:111], v[120:123], v[64:67], 0
    v_mfma_f32_16x16x32_bf16 v[108:111], v[124:127], v[68:71], v[108:111]
    v_lshrrev_b32 v29, 4, v0
    v_and_b32 v28, 0x30, v3
    v_lshl_add_u32 v12, v29, 6, v28
    s_min_u32 s90, s56, 27
    s_lshl_b32 s90, s90, 3
    s_add_u32 s90, s90, s3
    s_lshl_b32 s90, s90, 8
    s_add_u32 s97, s90, 3407872
    buffer_load_dwordx4 v[64:67], v12, s[28:31], s97 offen sc1
    s_cmp_gt_i32 s89, 1210
    s_cbranch_scc1 L_sk62
    s_waitcnt vmcnt(3)
L_sk62:
    s_waitcnt vmcnt(8)
    buffer_load_dwordx4 v[200:203], v3, s[8:11], s45 offen offset:2048 nt
    s_waitcnt lgkmcnt(0)
    s_sub_u32 s89, s86, s88
    s_memrealtime s[86:87]
    s_cmp_gt_i32 s89, 1239
    s_cbranch_scc1 L_sk63
    s_waitcnt vmcnt(3)
L_sk63:
    s_waitcnt vmcnt(8)
    buffer_load_dwordx4 v[204:207], v3, s[8:11], s45 offen offset:3072 nt
    s_cmp_gt_i32 s89, 1268
    s_cbranch_scc1 L_sk64
    s_waitcnt vmcnt(3)
L_sk64:
    s_waitcnt vmcnt(8)
    s_add_u32 s45, s43, 163840
    buffer_load_dwordx4 v[208:211], v3, s[8:11], s45 offen offset:0 nt
    s_waitcnt vmcnt(6)
    v_perm_b32 v112, v164, v160, s50
    v_perm_b32 v116, v164, v160, s51
    v_perm_b32 v113, v172, v168, s50
    v_perm_b32 v117, v172, v168, s51
    v_perm_b32 v114, v180, v176, s50
    v_perm_b32 v118, v180, v176, s51
    v_perm_b32 v115, v188, v184, s50
    v_perm_b32 v119, v188, v184, s51
    s_nop 0
    v_mfma_f32_16x16x32_bf16 v[96:99], v[112:115], v[72:75], v[96:99]
    v_mfma_f32_16x16x32_bf16 v[96:99], v[116:119], v[76:79], v[96:99]
    v_perm_b32 v120, v165, v161, s50
    v_perm_b32 v124, v165, v161, s51
    v_perm_b32 v121, v173, v169, s50
    v_perm_b32 v125, v173, v169, s51
    v_perm_b32 v122, v181, v177, s50
    v_perm_b32 v126, v181, v177, s51
    v_perm_b32 v123, v189, v185, s50
    v_perm_b32 v127, v189, v185, s51
    s_nop 0
    v_mfma_f32_16x16x32_bf16 v[100:103], v[120:123], v[72:75], v[100:103]
    v_mfma_f32_16x16x32_bf16 v[100:103], v[124:127], v[76:79], v[100:103]
    s_cmp_gt_i32 s89, 1297
    s_cbranch_scc1 L_sk65
    s_waitcnt vmcnt(2)
L_sk65:
    buffer_load_dwordx4 v[212:215], v3, s[8:11], s45 offen offset:1024 nt
    v_perm_b32 v112, v166, v162, s50
    v_perm_b32 v116, v166, v162, s51
    v_perm_b32 v113, v174, v170, s50
    v_perm_b32 v117, v174, v170, s51
    v_perm_b32 v114, v182, v178, s50
    v_perm_b32 v118, v182, v178, s51
    v_perm_b32 v115, v190, v186, s50
    v_perm_b32 v119, v190, v186, s51
    s_nop 0
    v_mfma_f32_16x16x32_bf16 v[104:107], v[112:115], v[72:75], v[104:107]
    v_mfma_f32_16x16x32_bf16 v[104:107], v[116:119], v[76:79], v[104:107]
    v_perm_b32 v120, v167, v163, s50
    v_perm_b32 v124, v167, v163, s51
    v_perm_b32 v121, v175, v171, s50
    v_perm_b32 v125, v175, v171, s51
    v_perm_b32 v122, v183, v179, s50
    v_perm_b32 v126, v183, v179, s51
    v_perm_b32 v123, v191, v187, s50
    v_perm_b32 v127, v191, v187, s51
    s_nop 0
    v_mfma_f32_16x16x32_bf16 v[108:111], v[120:123], v[72:75], v[108:111]
    v_mfma_f32_16x16x32_bf16 v[108:111], v[124:127], v[76:79], v[108:111]
    s_waitcnt vmcnt(4)
    v_xor_b32 v27, s32, v64
    v_bitop3_b32 v27, v27, v65, s33 bitop3:0xf6
    v_bitop3_b32 v27, v27, v66, s34 bitop3:0xf6
    v_bitop3_b32 v27, v27, v67, s35 bitop3:0xf6
    v_and_b32 v27, 0xffff, v27
    v_cmp_ne_u32 vcc, 0, v27
    s_cbranch_vccz L_ok66
L_retry66:
    s_wqm_b64 exec, vcc
    s_sleep 1
    buffer_load_dwordx4 v[64:67], v12, s[28:31], s97 offen sc1
    s_waitcnt vmcnt(0)
    v_xor_b32 v27, s32, v64
    v_bitop3_b32 v27, v27, v65, s33 bitop3:0xf6
    v_bitop3_b32 v27, v27, v66, s34 bitop3:0xf6
    v_bitop3_b32 v27, v27, v67, s35 bitop3:0xf6
    v_and_b32 v27, 0xffff, v27
    v_cmp_ne_u32 vcc, 0, v27
    s_sub_u32 s58, s58, 1
    s_cbranch_scc1 L_giveup66
    s_cbranch_vccnz L_retry66
    s_branch L_fix66
L_giveup66:
    s_mov_b32 s58, 0
L_fix66:
    s_mov_b64 exec, -1
L_ok66:
    v_perm_b32 v12, v65, v64, s51
    v_perm_b32 v13, v67, v66, s51
    s_waitcnt lgkmcnt(0)
    s_sub_u32 s89, s86, s88
    s_memrealtime s[86:87]
    s_cmp_gt_i32 s89, 1326
    s_cbranch_scc1 L_sk67
    s_waitcnt vmcnt(2)
L_sk67:
    buffer_load_dwordx4 v[216:219], v3, s[8:11], s45 offen offset:2048 nt
    s_cmp_gt_i32 s89, 1355
    s_cbranch_scc1 L_sk68
    s_waitcnt vmcnt(2)
L_sk68:
    buffer_load_dwordx4 v[220:223], v3, s[8:11], s45 offen offset:3072 nt
    s_cmp_gt_i32 s89, 1384
    s_cbranch_scc1 L_sk69
    s_waitcnt vmcnt(2)
L_sk69:
    s_add_u32 s45, s43, 196608
    buffer_load_dwordx4 v[224:227], v3, s[8:11], s45 offen offset:0 nt
    s_waitcnt lgkmcnt(0)
    s_sub_u32 s89, s86, s88
    s_memrealtime s[86:87]
    s_cmp_gt_i32 s89, 1413
    s_cbranch_scc1 L_sk70
    s_waitcnt vmcnt(2)
L_sk70:
    buffer_load_dwordx4 v[228:231], v3, s[8:11], s45 offen offset:1024 nt
    s_cmp_gt_i32 s89, 1442
    s_cbranch_scc1 L_sk71
    s_waitcnt vmcnt(2)
L_sk71:
    s_waitcnt vmcnt(7)
    buffer_load_dwordx4 v[232:235], v3, s[8:11], s45 offen offset:2048 nt
    s_cmp_gt_i32 s89, 1471
    s_cbranch_scc1 L_sk72
    s_waitcnt vmcnt(2)
L_sk72:
    s_waitcnt vmcnt(7)
    buffer_load_dwordx4 v[236:239], v3, s[8:11], s45 offen offset:3072 nt
    s_waitcnt lgkmcnt(0)
    s_sub_u32 s89, s86, s88
    s_memrealtime s[86:87]
    s_cmp_gt_i32 s89, 1500
    s_cbranch_scc1 L_sk73
    s_waitcnt vmcnt(2)
L_sk73:
    s_waitcnt vmcnt(7)
    s_add_u32 s45, s43, 229376
    buffer_load_dwordx4 v[240:243], v3, s[8:11], s45 offen offset:0 nt
    s_waitcnt vmcnt(5)
    v_perm_b32 v112, v196, v192, s50
    v_perm_b32 v116, v196, v192, s51
    v_perm_b32 v113, v204, v200, s50
    v_perm_b32 v117, v204, v200, s51
    v_perm_b32 v114, v212, v208, s50
    v_perm_b32 v118, v212, v208, s51
    v_perm_b32 v115, v220, v216, s50
    v_perm_b32 v119, v220, v216, s51
    s_nop 0
    v_mfma_f32_16x16x32_bf16 v[96:99], v[112:115], v[80:83], v[96:99]
    v_mfma_f32_16x16x32_bf16 v[96:99], v[116:119], v[84:87], v[96:99]
    v_perm_b32 v120, v197, v193, s50
    v_perm_b32 v124, v197, v193, s51
    v_perm_b32 v121, v205, v201, s50
    v_perm_b32 v125, v205, v201, s51
    v_perm_b32 v122, v213, v209, s50
    v_perm_b32 v126, v213, v209, s51
    v_perm_b32 v123, v221, v217, s50
    v_perm_b32 v127, v221, v217, s51
    s_nop 0
    v_mfma_f32_16x16x32_bf16 v[100:103], v[120:123], v[80:83], v[100:103]
    v_mfma_f32_16x16x32_bf16 v[100:103], v[124:127], v[84:87], v[100:103]
    s_cmp_gt_i32 s89, 1529
    s_cbranch_scc1 L_sk74
    s_waitcnt vmcnt(2)
L_sk74:
    buffer_load_dwordx4 v[244:247], v3, s[8:11], s45 offen offset:1024 nt
    v_perm_b32 v112, v198, v194, s50
    v_perm_b32 v116, v198, v194, s51
    v_perm_b32 v113, v206, v202, s50
    v_perm_b32 v117, v206, v202, s51
    v_perm_b32 v114, v214, v210, s50
    v_perm_b32 v118, v214, v210, s51
    v_perm_b32 v115, v222, v218, s50
    v_perm_b32 v119, v222, v218, s51
    s_nop 0
    v_mfma_f32_16x16x32_bf16 v[104:107], v[112:115], v[80:83], v[104:107]
    v_mfma_f32_16x16x32_bf16 v[104:107], v[116:119], v[84:87], v[104:107]
    v_perm_b32 v120, v199, v195, s50
    v_perm_b32 v124, v199, v195, s51
    v_perm_b32 v121, v207, v203, s50
    v_perm_b32 v125, v207, v203, s51
    v_perm_b32 v122, v215, v211, s50
    v_perm_b32 v126, v215, v211, s51
    v_perm_b32 v123, v223, v219, s50
    v_perm_b32 v127, v223, v219, s51
    s_nop 0
    v_mfma_f32_16x16x32_bf16 v[108:111], v[120:123], v[80:83], v[108:111]
    v_mfma_f32_16x16x32_bf16 v[108:111], v[124:127], v[84:87], v[108:111]
    s_lshr_b32 s99, s47, 4
    s_lshl_b32 s99, s99, 11
    s_add_u32 s99, s99, 1114112
    buffer_load_dwordx4 v[64:67], v3, s[28:31], s99 offen offset:0 sc1
    buffer_load_dwordx4 v[68:71], v3, s[28:31], s99 offen offset:1024 sc1
    s_lshl_b32 s91, s47, 12
    s_lshl_b32 s92, s3, 9
    s_add_u32 s91, s91, s92
    s_add_u32 s91, s91, 1179648
    s_lshl_b32 s94, s59, 15
    s_lshl_b32 s92, s100, 9
    s_add_u32 s94, s94, s92
    s_lshl_b32 s93, s3, 7
    s_add_u32 s94, s94, s93
    s_add_u32 s94, s94, 1179648
    s_and_b32 s95, s59, 1
    s_lshl_b32 s95, s95, 16
    s_lshr_b32 s90, s59, 3
    s_lshl_b32 s90, s90, 14
    s_add_u32 s95, s95, s90
    s_bfe_u32 s90, s59, 0x20001
    s_lshl_b32 s90, s90, 12
    s_add_u32 s95, s95, s90
    s_add_u32 s95, s95, s92
    s_add_u32 s95, s95, s93
    s_add_u32 s95, s95, 3276800
    s_lshl_b32 s96, s56, 9
    s_lshl_b32 s92, s3, 6
    s_add_u32 s96, s96, s92
    s_add_u32 s96, s96, 3276800
    s_lshl_b32 s98, s57, 5
    s_add_u32 s98, s98, s56
    s_lshl_b32 s98, s98, 11
    s_lshl_b32 s92, s3, 8
    s_add_u32 s98, s98, s92
    s_add_u32 s98, s98, 2228224
    v_perm_b32 v160, v13, v12, v17
    v_perm_b32 v161, v13, v12, v18
    v_perm_b32 v162, v13, v12, v19
    v_perm_b32 v163, v13, v12, v20
    v_perm_b32 v164, v13, v12, v21
    v_perm_b32 v165, v13, v12, v22
    v_perm_b32 v166, v13, v12, v23
    v_perm_b32 v167, v13, v12, v24
    s_waitcnt vmcnt(6)
    v_perm_b32 v128, v228, v224, s50
    v_perm_b32 v132, v228, v224, s51
    v_perm_b32 v136, v229, v225, s50
    v_perm_b32 v140, v229, v225, s51
    v_perm_b32 v144, v230, v226, s50
    v_perm_b32 v148, v230, v226, s51
    v_perm_b32 v152, v231, v227, s50
    v_perm_b32 v156, v231, v227, s51
    s_waitcnt vmcnt(4)
    v_perm_b32 v129, v236, v232, s50
    v_perm_b32 v133, v236, v232, s51
    v_perm_b32 v137, v237, v233, s50
    v_perm_b32 v141, v237, v233, s51
    v_perm_b32 v145, v238, v234, s50
    v_perm_b32 v149, v238, v234, s51
    v_perm_b32 v153, v239, v235, s50
    v_perm_b32 v157, v239, v235, s51
    buffer_load_dwordx4 v[248:251], v3, s[8:11], s45 offen offset:2048 nt
    s_waitcnt lgkmcnt(0)
    s_sub_u32 s89, s86, s88
    s_memrealtime s[86:87]
    s_cmp_gt_i32 s89, 1587
    s_cbranch_scc1 L_sk76
    s_waitcnt vmcnt(4)
L_sk76:
    buffer_load_dwordx4 v[252:255], v3, s[8:11], s45 offen offset:3072 nt
    s_waitcnt vmcnt(4)
    v_perm_b32 v130, v244, v240, s50
    v_perm_b32 v134, v244, v240, s51
    v_perm_b32 v138, v245, v241, s50
    v_perm_b32 v142, v245, v241, s51
    v_perm_b32 v146, v246, v242, s50
    v_perm_b32 v150, v246, v242, s51
    v_perm_b32 v154, v247, v243, s50
    v_perm_b32 v158, v247, v243, s51
    s_waitcnt vmcnt(2)
    v_xor_b32 v27, s32, v64
    v_bitop3_b32 v27, v27, v65, s33 bitop3:0xf6
    v_bitop3_b32 v27, v27, v66, s34 bitop3:0xf6
    v_bitop3_b32 v27, v27, v67, s35 bitop3:0xf6
    v_bitop3_b32 v27, v27, v68, s32 bitop3:0xf6
    v_bitop3_b32 v27, v27, v69, s33 bitop3:0xf6
    v_bitop3_b32 v27, v27, v70, s34 bitop3:0xf6
    v_bitop3_b32 v27, v27, v71, s35 bitop3:0xf6
    v_and_b32 v27, 0xff, v27
    v_cmp_ne_u32 vcc, 0, v27
    s_cbranch_vccz L_ok77
L_retry77:
    s_wqm_b64 exec, vcc
    s_sleep 1
    buffer_load_dwordx4 v[64:67], v3, s[28:31], s99 offen offset:0 sc1
    buffer_load_dwordx4 v[68:71], v3, s[28:31], s99 offen offset:1024 sc1
    s_waitcnt vmcnt(0)
    v_xor_b32 v27, s32, v64
    v_bitop3_b32 v27, v27, v65, s33 bitop3:0xf6
    v_bitop3_b32 v27, v27, v66, s34 bitop3:0xf6
    v_bitop3_b32 v27, v27, v67, s35 bitop3:0xf6
    v_bitop3_b32 v27, v27, v68, s32 bitop3:0xf6
    v_bitop3_b32 v27, v27, v69, s33 bitop3:0xf6
    v_bitop3_b32 v27, v27, v70, s34 bitop3:0xf6
    v_bitop3_b32 v27, v27, v71, s35 bitop3:0xf6
    v_and_b32 v27, 0xff, v27
    v_cmp_ne_u32 vcc, 0, v27
    s_sub_u32 s58, s58, 1
    s_cbranch_scc1 L_giveup77
    s_cbranch_vccnz L_retry77
    s_branch L_fix77
L_giveup77:
    s_mov_b32 s58, 0
L_fix77:
    s_mov_b64 exec, -1
L_ok77:
    v_and_b32 v64, s53, v64
    v_and_b32 v68, s53, v68
    v_and_b32 v65, s52, v65
    v_and_b32 v69, s52, v69
    v_max_f32 v29, v64, v68
    s_nop 1
    v_max_f32_dpp v29, v29, v29 row_ror:8 row_mask:0xf bank_mask:0xf
    v_mov_b32 v28, v29
    s_nop 1
    v_permlane16_swap_b32 v28, v29
    v_max_f32 v29, v29, v28
    v_mov_b32 v28, v29
    s_nop 1
    v_permlane32_swap_b32 v28, v29
    v_max_f32 v29, v29, v28
    v_sub_f32 v64, v64, v29
    v_sub_f32 v68, v68, v29
    v_sub_f32 v4, v4, v29
    v_mul_f32 v64, s55, v64
    v_mul_f32 v68, s55, v68
    v_mul_f32 v4, s55, v4
    v_exp_f32 v64, v64
    v_exp_f32 v68, v68
    v_exp_f32 v4, v4
    v_mul_f32 v65, v65, v64
    v_fmac_f32 v65, v69, v68
    s_nop 1
    v_add_f32_dpp v65, v65, v65 row_ror:8 row_mask:0xf bank_mask:0xf
    v_mov_b32 v28, v65
    s_nop 1
    v_permlane16_swap_b32 v28, v65
    v_add_f32 v65, v65, v28
    v_mov_b32 v28, v65
    s_nop 1
    v_permlane32_swap_b32 v28, v65
    v_add_f32 v65, v65, v28
    v_rcp_f32 v65, v65
    s_nop 0
    v_mul_f32 v4, v4, v65
    v_mov_b32 v5, v4
    buffer_load_dwordx4 v[48:51], v14, s[20:23], s63 offen nt
    s_waitcnt lgkmcnt(0)
    s_sub_u32 s89, s86, s88
    s_memrealtime s[86:87]
    s_cmp_gt_i32 s89, 1645
    s_cbranch_scc1 L_sk79
    s_waitcnt vmcnt(2)
L_sk79:
    s_add_u32 s63, s63, 16384
    buffer_load_dwordx4 v[52:55], v14, s[20:23], s63 offen nt
    s_waitcnt vmcnt(2)
    v_perm_b32 v131, v252, v248, s50
    v_perm_b32 v135, v252, v248, s51
    v_perm_b32 v139, v253, v249, s50
    v_perm_b32 v143, v253, v249, s51
    v_perm_b32 v147, v254, v250, s50
    v_perm_b32 v151, v254, v250, s51
    v_perm_b32 v155, v255, v251, s50
    v_perm_b32 v159, v255, v251, s51
    v_mfma_f32_16x16x32_bf16 v[96:99], v[128:131], v[88:91], v[96:99]
    v_mfma_f32_16x16x32_bf16 v[100:103], v[136:139], v[88:91], v[100:103]
    v_mfma_f32_16x16x32_bf16 v[104:107], v[144:147], v[88:91], v[104:107]
    v_mfma_f32_16x16x32_bf16 v[108:111], v[152:155], v[88:91], v[108:111]
    v_mfma_f32_16x16x32_bf16 v[96:99], v[132:135], v[92:95], v[96:99]
    v_mfma_f32_16x16x32_bf16 v[100:103], v[140:143], v[92:95], v[100:103]
    v_mfma_f32_16x16x32_bf16 v[104:107], v[148:151], v[92:95], v[104:107]
    v_mfma_f32_16x16x32_bf16 v[108:111], v[156:159], v[92:95], v[108:111]
    s_add_u32 s63, s63, 16384
    buffer_load_dwordx4 v[56:59], v14, s[20:23], s63 offen nt
    s_nop 2
    v_pk_mul_f32 v[96:97], v[96:97], v[4:5]
    v_pk_mul_f32 v[98:99], v[98:99], v[4:5]
    ds_write_b128 v6, v[96:99] offset:0
    v_pk_mul_f32 v[100:101], v[100:101], v[4:5]
    v_pk_mul_f32 v[102:103], v[102:103], v[4:5]
    ds_write_b128 v6, v[100:103] offset:128
    v_pk_mul_f32 v[104:105], v[104:105], v[4:5]
    v_pk_mul_f32 v[106:107], v[106:107], v[4:5]
    ds_write_b128 v6, v[104:107] offset:256
    v_pk_mul_f32 v[108:109], v[108:109], v[4:5]
    v_pk_mul_f32 v[110:111], v[110:111], v[4:5]
    ds_write_b128 v6, v[108:111] offset:384
    s_waitcnt lgkmcnt(0)
    s_barrier
    ds_read_b128 v[192:195], v7 offset:0
    ds_read_b128 v[196:199], v7 offset:16384
    ds_read_b128 v[200:203], v7 offset:32768
    ds_read_b128 v[204:207], v7 offset:49152
    s_waitcnt lgkmcnt(2)
    v_pk_add_f32 v[192:193], v[192:193], v[196:197]
    v_pk_add_f32 v[194:195], v[194:195], v[198:199]
    s_waitcnt lgkmcnt(0)
    v_pk_add_f32 v[200:201], v[200:201], v[204:205]
    v_pk_add_f32 v[202:203], v[202:203], v[206:207]
    v_pk_add_f32 v[192:193], v[192:193], v[200:201]
    v_pk_add_f32 v[194:195], v[194:195], v[202:203]
    v_mov_b32 v196, v192
    v_mov_b32 v197, v193
    v_mov_b32 v198, v194
    v_mov_b32 v199, v195
    v_permlane32_swap_b32 v196, v192
    v_permlane32_swap_b32 v197, v193
    v_permlane32_swap_b32 v198, v194
    v_permlane32_swap_b32 v199, v195
    v_add_f32 v192, v192, v196
    v_add_f32 v193, v193, v197
    v_add_f32 v194, v194, v198
    v_add_f32 v195, v195, v199
    v_bfi_b32 v192, v1, s32, v192
    v_bfi_b32 v193, v1, s33, v193
    v_bfi_b32 v194, v1, s34, v194
    v_bfi_b32 v195, v1, s35, v195
    s_mov_b32 exec_hi, 0
    s_bitcmp1_b32 s48, 0
    s_cbranch_scc1 L_ls80
    buffer_store_dwordx4 v[192:195], v3, s[28:31], s91 offen sc1
    s_branch L_le80
L_ls80:
    buffer_store_dwordx4 v[192:195], v3, s[28:31], s91 offen
L_le80:
    s_mov_b32 exec_hi, -1
    s_cmp_lt_u32 s3, 4
    s_cselect_b32 s14, s30, 0
    s_sleep 4
    s_mov_b32 s93, 0
    s_cmp_ge_u32 s3, 4
    s_cbranch_scc1 L_hold_81
    s_bitcmp1_b32 s48, 0
    s_cbranch_scc1 L_ls82
    buffer_load_dwordx4 v[208:211], v16, s[12:15], s94 offen sc1
    s_branch L_le82
L_ls82:
    buffer_load_dwordx4 v[208:211], v16, s[12:15], s94 offen nt
L_le82:
    s_waitcnt vmcnt(0)
    v_xor_b32 v27, s32, v208
    v_bitop3_b32 v27, v27, v209, s33 bitop3:0xf6
    v_bitop3_b32 v27, v27, v210, s34 bitop3:0xf6
    v_bitop3_b32 v27, v27, v211, s35 bitop3:0xf6
    v_and_b32 v27, 0xff, v27
    v_cmp_ne_u32 vcc, 0, v27
    s_cbranch_vccz L_t2ok81
    s_bitcmp1_b32 s48, 0
    s_cbranch_scc1 L_ls83
    buffer_load_dwordx4 v[208:211], v16, s[12:15], s94 offen sc1
    s_branch L_le83
L_ls83:
    buffer_load_dwordx4 v[208:211], v16, s[12:15], s94 offen nt
L_le83:
    s_waitcnt vmcnt(0)
    v_xor_b32 v27, s32, v208
    v_bitop3_b32 v27, v27, v209, s33 bitop3:0xf6
    v_bitop3_b32 v27, v27, v210, s34 bitop3:0xf6
    v_bitop3_b32 v27, v27, v211, s35 bitop3:0xf6
    v_and_b32 v27, 0xff, v27
    v_cmp_ne_u32 vcc, 0, v27
    s_cbranch_vccz L_t2ok81
    s_bitcmp1_b32 s48, 0
    s_cbranch_scc1 L_ls84
    buffer_load_dwordx4 v[208:211], v16, s[12:15], s94 offen sc1
    s_branch L_le84
L_ls84:
    buffer_load_dwordx4 v[208:211], v16, s[12:15], s94 offen nt
L_le84:
    s_waitcnt vmcnt(0)
    v_xor_b32 v27, s32, v208
    v_bitop3_b32 v27, v27, v209, s33 bitop3:0xf6
    v_bitop3_b32 v27, v27, v210, s34 bitop3:0xf6
    v_bitop3_b32 v27, v27, v211, s35 bitop3:0xf6
    v_and_b32 v27, 0xff, v27
    v_cmp_ne_u32 vcc, 0, v27
    s_cbranch_vccz L_t2ok81
    s_add_u32 s63, s63, 16384
    buffer_load_dwordx4 v[60:63], v14, s[20:23], s63 offen nt
    buffer_load_dwordx4 v[32:35], v14, s[24:27], s62 offen nt
    s_add_u32 s62, s62, 16384
    buffer_load_dwordx4 v[36:39], v14, s[24:27], s62 offen nt
    s_add_u32 s62, s62, 16384
    buffer_load_dwordx4 v[40:43], v14, s[24:27], s62 offen nt
    s_add_u32 s62, s62, 16384
    buffer_load_dwordx4 v[44:47], v14, s[24:27], s62 offen nt
    s_mov_b32 s93, 1
    v_xor_b32 v27, s32, v208
    v_bitop3_b32 v27, v27, v209, s33 bitop3:0xf6
    v_bitop3_b32 v27, v27, v210, s34 bitop3:0xf6
    v_bitop3_b32 v27, v27, v211, s35 bitop3:0xf6
    v_and_b32 v27, 0xff, v27
    v_cmp_ne_u32 vcc, 0, v27
    s_cbranch_vccz L_ok85
L_retry85:
    s_wqm_b64 exec, vcc
    s_sleep 1
    s_bitcmp1_b32 s48, 0
    s_cbranch_scc1 L_ls86
    buffer_load_dwordx4 v[208:211], v16, s[12:15], s94 offen sc1
    s_branch L_le86
L_ls86:
    buffer_load_dwordx4 v[208:211], v16, s[12:15], s94 offen nt
L_le86:
    s_waitcnt vmcnt(0)
    v_xor_b32 v27, s32, v208
    v_bitop3_b32 v27, v27, v209, s33 bitop3:0xf6
    v_bitop3_b32 v27, v27, v210, s34 bitop3:0xf6
    v_bitop3_b32 v27, v27, v211, s35 bitop3:0xf6
    v_and_b32 v27, 0xff, v27
    v_cmp_ne_u32 vcc, 0, v27
    s_sub_u32 s58, s58, 1
    s_cbranch_scc1 L_giveup85
    s_cbranch_vccnz L_retry85
    s_branch L_fix85
L_giveup85:
    s_mov_b32 s58, 0
L_fix85:
    s_mov_b64 exec, -1
L_ok85:
L_t2ok81:
    v_add_f32_dpp v208, v208, v208 row_ror:8 row_mask:0xf bank_mask:0xf
    v_add_f32_dpp v209, v209, v209 row_ror:8 row_mask:0xf bank_mask:0xf
    v_add_f32_dpp v210, v210, v210 row_ror:8 row_mask:0xf bank_mask:0xf
    v_add_f32_dpp v211, v211, v211 row_ror:8 row_mask:0xf bank_mask:0xf
    v_mov_b32 v212, v208
    v_mov_b32 v213, v209
    v_mov_b32 v214, v210
    v_mov_b32 v215, v211
    v_permlane16_swap_b32 v212, v208
    v_permlane16_swap_b32 v213, v209
    v_permlane16_swap_b32 v214, v210
    v_permlane16_swap_b32 v215, v211
    v_add_f32 v208, v208, v212
    v_add_f32 v209, v209, v213
    v_add_f32 v210, v210, v214
    v_add_f32 v211, v211, v215
    v_mov_b32 v212, v208
    v_mov_b32 v213, v209
    v_mov_b32 v214, v210
    v_mov_b32 v215, v211
    v_permlane32_swap_b32 v212, v208
    v_permlane32_swap_b32 v213, v209
    v_permlane32_swap_b32 v214, v210
    v_permlane32_swap_b32 v215, v211
    v_add_f32 v208, v208, v212
    v_add_f32 v209, v209, v213
    v_add_f32 v210, v210, v214
    v_add_f32 v211, v211, v215
    v_bfi_b32 v208, v1, s32, v208
    v_bfi_b32 v209, v1, s33, v209
    v_bfi_b32 v210, v1, s34, v210
    v_bfi_b32 v211, v1, s35, v211
    s_mov_b64 exec, 0xff
    buffer_store_dwordx4 v[208:211], v3, s[28:31], s95 offen sc1
    s_mov_b64 exec, -1
    s_cmp_eq_u32 s93, 1
    s_cbranch_scc1 L_wdone81
    s_add_u32 s63, s63, 16384
    buffer_load_dwordx4 v[60:63], v14, s[20:23], s63 offen nt
    buffer_load_dwordx4 v[32:35], v14, s[24:27], s62 offen nt
    s_add_u32 s62, s62, 16384
    buffer_load_dwordx4 v[36:39], v14, s[24:27], s62 offen nt
    s_add_u32 s62, s62, 16384
    buffer_load_dwordx4 v[40:43], v14, s[24:27], s62 offen nt
    s_add_u32 s62, s62, 16384
    buffer_load_dwordx4 v[44:47], v14, s[24:27], s62 offen nt
    s_branch L_wdone81
L_hold_81:
    s_sleep 4
L_not2_81:
    s_add_u32 s63, s63, 16384
    buffer_load_dwordx4 v[60:63], v14, s[20:23], s63 offen nt
    buffer_load_dwordx4 v[32:35], v14, s[24:27], s62 offen nt
    s_add_u32 s62, s62, 16384
    buffer_load_dwordx4 v[36:39], v14, s[24:27], s62 offen nt
    s_add_u32 s62, s62, 16384
    buffer_load_dwordx4 v[40:43], v14, s[24:27], s62 offen nt
    s_add_u32 s62, s62, 16384
    buffer_load_dwordx4 v[44:47], v14, s[24:27], s62 offen nt
L_wdone81:
    s_waitcnt vmcnt(3)
    v_mfma_f32_16x16x16_bf16 v[184:187], v[32:33], v[160:161], 0
    v_mfma_f32_16x16x16_bf16 v[188:191], v[34:35], v[160:161], 0
    s_waitcnt vmcnt(2)
    v_mfma_f32_16x16x16_bf16 v[184:187], v[36:37], v[162:163], v[184:187]
    v_mfma_f32_16x16x16_bf16 v[188:191], v[38:39], v[162:163], v[188:191]
    buffer_load_dwordx4 v[216:219], v8, s[28:31], s96 offen sc1
    s_waitcnt vmcnt(2)
    v_mfma_f32_16x16x16_bf16 v[184:187], v[40:41], v[164:165], v[184:187]
    v_mfma_f32_16x16x16_bf16 v[188:191], v[42:43], v[164:165], v[188:191]
    s_waitcnt vmcnt(1)
    v_mfma_f32_16x16x16_bf16 v[184:187], v[44:45], v[166:167], v[184:187]
    v_mfma_f32_16x16x16_bf16 v[188:191], v[46:47], v[166:167], v[188:191]
    s_waitcnt vmcnt(0)
    v_xor_b32 v27, s32, v216
    v_bitop3_b32 v27, v27, v217, s33 bitop3:0xf6
    v_bitop3_b32 v27, v27, v218, s34 bitop3:0xf6
    v_bitop3_b32 v27, v27, v219, s35 bitop3:0xf6
    v_and_b32 v27, 0xff, v27
    v_cmp_ne_u32 vcc, 0, v27
    s_cbranch_vccz L_ok87
L_retry87:
    s_wqm_b64 exec, vcc
    s_sleep 2
    buffer_load_dwordx4 v[216:219], v8, s[28:31], s96 offen sc1
    s_waitcnt vmcnt(0)
    v_xor_b32 v27, s32, v216
    v_bitop3_b32 v27, v27, v217, s33 bitop3:0xf6
    v_bitop3_b32 v27, v27, v218, s34 bitop3:0xf6
    v_bitop3_b32 v27, v27, v219, s35 bitop3:0xf6
    v_and_b32 v27, 0xff, v27
    v_cmp_ne_u32 vcc, 0, v27
    s_sub_u32 s58, s58, 1
    s_cbranch_scc1 L_giveup87
    s_cbranch_vccnz L_retry87
    s_branch L_fix87
L_giveup87:
    s_mov_b32 s58, 0
L_fix87:
    s_mov_b64 exec, -1
L_ok87:
    v_add_f32_dpp v216, v216, v216 row_ror:4 row_mask:0xf bank_mask:0xf
    v_add_f32_dpp v217, v217, v217 row_ror:4 row_mask:0xf bank_mask:0xf
    v_add_f32_dpp v218, v218, v218 row_ror:4 row_mask:0xf bank_mask:0xf
    v_add_f32_dpp v219, v219, v219 row_ror:4 row_mask:0xf bank_mask:0xf
    v_cvt_pk_bf16_f32 v216, v216, v217
    v_cvt_pk_bf16_f32 v217, v218, v219
    ds_bpermute_b32 v218, v15, v216
    ds_bpermute_b32 v219, v15, v217
    s_waitcnt lgkmcnt(0)
    v_perm_b32 v168, v219, v218, v17
    v_perm_b32 v169, v219, v218, v18
    v_perm_b32 v170, v219, v218, v19
    v_perm_b32 v171, v219, v218, v20
    v_perm_b32 v172, v219, v218, v21
    v_perm_b32 v173, v219, v218, v22
    v_perm_b32 v174, v219, v218, v23
    v_perm_b32 v175, v219, v218, v24
    v_mfma_f32_16x16x16_bf16 v[184:187], v[48:49], v[168:169], v[184:187]
    v_mfma_f32_16x16x16_bf16 v[188:191], v[50:51], v[168:169], v[188:191]
    v_mfma_f32_16x16x16_bf16 v[184:187], v[52:53], v[170:171], v[184:187]
    v_mfma_f32_16x16x16_bf16 v[188:191], v[54:55], v[170:171], v[188:191]
    v_mfma_f32_16x16x16_bf16 v[184:187], v[56:57], v[172:173], v[184:187]
    v_mfma_f32_16x16x16_bf16 v[188:191], v[58:59], v[172:173], v[188:191]
    v_mfma_f32_16x16x16_bf16 v[184:187], v[60:61], v[174:175], v[184:187]
    v_mfma_f32_16x16x16_bf16 v[188:191], v[62:63], v[174:175], v[188:191]
    s_nop 6
    ds_write_b128 v9, v[184:187] offset:8192
    ds_write_b128 v9, v[188:191] offset:9216
    s_lshl_b32 s90, s57, 16
    s_lshl_b32 s91, s56, 6
    s_add_u32 s90, s90, s91
    s_add_u32 s94, s90, 2228224
    s_add_u32 s95, s90, 2260992
    s_waitcnt lgkmcnt(0)
    s_barrier
    ds_read_b128 v[192:195], v10 offset:8192
    ds_read_b128 v[196:199], v10 offset:24576
    s_waitcnt lgkmcnt(0)
    v_pk_add_f32 v[192:193], v[192:193], v[196:197]
    v_pk_add_f32 v[194:195], v[194:195], v[198:199]
    v_mov_b32 v196, v192
    v_mov_b32 v197, v193
    v_mov_b32 v198, v194
    v_mov_b32 v199, v195
    v_permlane16_swap_b32 v196, v192
    v_permlane16_swap_b32 v197, v193
    v_permlane16_swap_b32 v198, v194
    v_permlane16_swap_b32 v199, v195
    v_add_f32 v192, v192, v196
    v_add_f32 v193, v193, v197
    v_add_f32 v194, v194, v198
    v_add_f32 v195, v195, v199
    v_mov_b32 v196, v192
    v_mov_b32 v197, v193
    v_mov_b32 v198, v194
    v_mov_b32 v199, v195
    v_permlane32_swap_b32 v196, v192
    v_permlane32_swap_b32 v197, v193
    v_permlane32_swap_b32 v198, v194
    v_permlane32_swap_b32 v199, v195
    v_add_f32 v192, v192, v196
    v_add_f32 v193, v193, v197
    v_add_f32 v194, v194, v198
    v_add_f32 v195, v195, v199
    v_bfi_b32 v192, v1, s32, v192
    v_bfi_b32 v193, v1, s33, v193
    v_bfi_b32 v194, v1, s34, v194
    v_bfi_b32 v195, v1, s35, v195
    s_mov_b64 exec, 0xffff
    s_bitcmp1_b32 s48, 1
    s_cbranch_scc1 L_ls88
    buffer_store_dwordx4 v[192:195], v3, s[28:31], s98 offen sc1
    s_branch L_le88
L_ls88:
    buffer_store_dwordx4 v[192:195], v3, s[28:31], s98 offen
L_le88:
    s_mov_b64 exec, -1
    s_cmp_lg_u32 s3, 0
    s_cbranch_scc1 L_end
    v_bfe_u32 v31, v0, 2, 2
    v_lshlrev_b32 v30, 4, v31
    v_add_u32 v30, s42, v30
    v_and_b32 v28, 3, v0
    v_lshl_add_u32 v30, v28, 11, v30
    s_mov_b32 s90, 0x00f000f0
    s_mov_b32 s91, s90
    s_mov_b32 s92, 0x0f000f00
    s_mov_b32 s93, s92
    s_mov_b32 s98, 0xf000f000
    s_mov_b32 s99, s98
    s_sleep 4
    s_bitcmp1_b32 s48, 1
    s_cbranch_scc1 L_ls89
    buffer_load_dwordx4 v[208:211], v11, s[28:31], s94 offen sc1
    buffer_load_dwordx4 v[212:215], v11, s[28:31], s95 offen sc1
    s_branch L_le89
L_ls89:
    buffer_load_dwordx4 v[208:211], v11, s[28:31], s94 offen nt
    buffer_load_dwordx4 v[212:215], v11, s[28:31], s95 offen nt
L_le89:
    s_waitcnt vmcnt(0)
    v_xor_b32 v27, s32, v208
    v_bitop3_b32 v27, v27, v209, s33 bitop3:0xf6
    v_bitop3_b32 v27, v27, v210, s34 bitop3:0xf6
    v_bitop3_b32 v27, v27, v211, s35 bitop3:0xf6
    v_bitop3_b32 v27, v27, v212, s32 bitop3:0xf6
    v_bitop3_b32 v27, v27, v213, s33 bitop3:0xf6
    v_bitop3_b32 v27, v27, v214, s34 bitop3:0xf6
    v_bitop3_b32 v27, v27, v215, s35 bitop3:0xf6
    v_and_b32 v27, 0xff, v27
    v_cmp_ne_u32 vcc, 0, v27
    s_cbranch_vccz L_ok90
L_retry90:
    s_wqm_b64 exec, vcc
    s_sleep 1
    s_bitcmp1_b32 s48, 1
    s_cbranch_scc1 L_ls91
    buffer_load_dwordx4 v[208:211], v11, s[28:31], s94 offen sc1
    buffer_load_dwordx4 v[212:215], v11, s[28:31], s95 offen sc1
    s_branch L_le91
L_ls91:
    buffer_load_dwordx4 v[208:211], v11, s[28:31], s94 offen nt
    buffer_load_dwordx4 v[212:215], v11, s[28:31], s95 offen nt
L_le91:
    s_waitcnt vmcnt(0)
    v_xor_b32 v27, s32, v208
    v_bitop3_b32 v27, v27, v209, s33 bitop3:0xf6
    v_bitop3_b32 v27, v27, v210, s34 bitop3:0xf6
    v_bitop3_b32 v27, v27, v211, s35 bitop3:0xf6
    v_bitop3_b32 v27, v27, v212, s32 bitop3:0xf6
    v_bitop3_b32 v27, v27, v213, s33 bitop3:0xf6
    v_bitop3_b32 v27, v27, v214, s34 bitop3:0xf6
    v_bitop3_b32 v27, v27, v215, s35 bitop3:0xf6
    v_and_b32 v27, 0xff, v27
    v_cmp_ne_u32 vcc, 0, v27
    s_sub_u32 s58, s58, 1
    s_cbranch_scc1 L_giveup90
    s_cbranch_vccnz L_retry90
    s_branch L_fix90
L_giveup90:
    s_mov_b32 s58, 0
L_fix90:
    s_mov_b64 exec, -1
L_ok90:
    v_pk_add_f32 v[208:209], v[208:209], v[212:213]
    v_pk_add_f32 v[210:211], v[210:211], v[214:215]
    s_nop 0
    v_add_f32_dpp v208, v208, v208 row_ror:4 row_mask:0xf bank_mask:0xf
    v_add_f32_dpp v209, v209, v209 row_ror:4 row_mask:0xf bank_mask:0xf
    v_add_f32_dpp v210, v210, v210 row_ror:4 row_mask:0xf bank_mask:0xf
    v_add_f32_dpp v211, v211, v211 row_ror:4 row_mask:0xf bank_mask:0xf
    v_add_f32_dpp v208, v208, v208 row_ror:8 row_mask:0xf bank_mask:0xf
    v_add_f32_dpp v209, v209, v209 row_ror:8 row_mask:0xf bank_mask:0xf
    v_add_f32_dpp v210, v210, v210 row_ror:8 row_mask:0xf bank_mask:0xf
    v_add_f32_dpp v211, v211, v211 row_ror:8 row_mask:0xf bank_mask:0xf
    v_cndmask_b32 v208, v208, v209, s[90:91]
    v_cndmask_b32 v208, v208, v210, s[92:93]
    v_cndmask_b32 v208, v208, v211, s[98:99]
    v_mov_b32 v209, v208
    s_nop 1
    v_permlane16_swap_b32 v209, v208
    v_add_f32 v208, v208, v209
    v_mov_b32 v209, v208
    s_nop 1
    v_permlane32_swap_b32 v209, v208
    v_add_f32 v208, v208, v209
    v_add_f32 v208, v208, v25
    v_cvt_pk_bf16_f32 v208, v208, v208
    s_mov_b64 exec, 0xffff
    global_store_short v30, v208, s[38:39]
    s_mov_b64 exec, 1
    s_cmp_lg_u32 s2, 0
    s_cbranch_scc1 L_end
    v_mov_b32 v27, 0
    global_store_dword v27, v2, s[40:41]
L_end:
    s_endpgm
L_codeend:
.fill (L_pcbase + 17408 - L_codeend) / 4, 4, 0xbf810000
.section .rodata,"a"
.p2align 6
.amdhsa_kernel parallel_sum__gqa_block_cached__mixer_channel_mlp__decode_kernel
  .amdhsa_next_free_vgpr 256
  .amdhsa_next_free_sgpr 102
  .amdhsa_accum_offset 256
  .amdhsa_group_segment_fixed_size 0
  .amdhsa_kernarg_size 104
  .amdhsa_user_sgpr_count 2
  .amdhsa_user_sgpr_kernarg_segment_ptr 1
  .amdhsa_system_sgpr_workgroup_id_x 1
.end_amdhsa_kernel
```
